```python
import torch

def _softmax(x, axis=-1):
    return torch.softmax(x, dim=axis)
def _gelu(x):
    return torch.nn.functional.gelu(x, approximate="tanh")
def _silu(x):
    return torch.nn.functional.silu(x)
def _sigmoid(x):
    return torch.sigmoid(x)
def _layernorm(x, axis=-1, eps=1e-5):
    m = x.mean(dim=axis, keepdim=True)
    v = x.var(dim=axis, keepdim=True, unbiased=False)
    return (x - m) / torch.sqrt(v + eps)
def _scatter_add(tgt, idx, src, axis=0):
    return tgt.clone().index_add_(axis, idx, src)
def _segment_sum(src, seg, n):
    out = torch.zeros((n,) + src.shape[1:], dtype=src.dtype)
    return out.index_add_(0, seg, src)
def _pad(x, pw):
    flat = tuple(v for pair in reversed(pw) for v in pair)
    return torch.nn.functional.pad(x, flat)

kernel_name = 'parallel_sum__sliding_block__glu_gated_bilinear__prompt'

def setup_inputs():

    _w = (lambda a: (lambda t: t.to(torch.bfloat16) if t.is_floating_point() else t)(torch.as_tensor(a)))
    def _A_setup():
        B, S, D = 1, 2048, 640
        return {
            "x": _w((lambda *s: torch.randn(*s, dtype=torch.bfloat16) * 0.05)(B, S, D)),
            "wqkv": _w((lambda *s: torch.randn(*s, dtype=torch.bfloat16) * 0.05)(D, 3 * D)),
            "wo": _w((lambda *s: torch.randn(*s, dtype=torch.bfloat16) * 0.05)(D, D)),
        }
    _A_in = _A_setup()

    def _B_setup():
        B, S, D, F = 1, 2048, 640, 1728
        return {
            "x": _w((lambda *s: torch.randn(*s, dtype=torch.bfloat16) * 0.05)(B, S, D)),
            "w_gate": _w((lambda *s: torch.randn(*s, dtype=torch.bfloat16) * 0.8)(D, F) * (D ** -0.5)),
            "w_up": _w((lambda *s: torch.randn(*s, dtype=torch.bfloat16) * 0.8)(D, F) * (D ** -0.5)),
            "w_down": _w((lambda *s: torch.randn(*s, dtype=torch.bfloat16) * 0.8)(F, D) * (F ** -0.5)),
        }
    _B_in = _B_setup()

    return {
        "A_x": _A_in["x"],
        "A_wqkv": _A_in["wqkv"],
        "A_wo": _A_in["wo"],
        "B_x": _B_in["x"],
        "B_w_gate": _B_in["w_gate"],
        "B_w_up": _B_in["w_up"],
        "B_w_down": _B_in["w_down"],
    }

def reference(A_x, A_wqkv, A_wo, B_x, B_w_gate, B_w_up, B_w_down):
    def _A_ref(x, wqkv, wo):
        B, S, D = x.shape
        H = 32; Dh = D // H; W = 256
        qkv = (lambda x, *d: x.permute(*d))((x @ wqkv).reshape(B, S, 3, H, Dh), 2, 0, 3, 1, 4)
        q, k, v = qkv[0], qkv[1], qkv[2]
        scores = torch.einsum("bhqd,bhkd->bhqk", q, k) * (Dh ** -0.5)
        idx = torch.arange(S)
        mask = (idx[:, None] - idx[None, :] >= 0) & (idx[:, None] - idx[None, :] < W)
        scores = torch.where(mask[None, None], scores, -1e9)
        p = _softmax(scores, axis=-1)
        o = torch.einsum("bhqk,bhkd->bhqd", p, v)
        return (lambda x, *d: x.permute(*d))(o, 0, 2, 1, 3).reshape(B, S, D) @ wo

    def _B_ref(x, w_gate, w_up, w_down):
        g = torch.einsum("bsd,df->bsf", x, w_gate)
        u = torch.einsum("bsd,df->bsf", x, w_up)
        h = g * u
        return torch.einsum("bsf,fd->bsd", h, w_down)

    x = A_x
    xn = _layernorm(x, axis=-1)
    return x + _A_ref(xn, A_wqkv, A_wo) + _B_ref(xn, B_w_gate, B_w_up, B_w_down)
```

```asm
; @launch grid=(256,1,1) block=(512,1,1) lds=163840
.amdgcn_target "amdgcn-amd-amdhsa--gfx950"
.text
.globl parallel_sum__sliding_block__glu_gated_bilinear__prompt_kernel
.p2align 8
.type parallel_sum__sliding_block__glu_gated_bilinear__prompt_kernel,@function
parallel_sum__sliding_block__glu_gated_bilinear__prompt_kernel:
  s_cmp_ge_u32 s2, 256
  s_cbranch_scc1 L_end
  s_load_dwordx16 s[4:19], s[0:1], 0
  s_load_dwordx4 s[20:23], s[0:1], 64
  v_lshrrev_b32 v1, 6, v0
  v_and_b32 v0, 63, v0
  v_readfirstlane_b32 s52, v1
  s_and_b32 s64, s2, 7
  s_lshr_b32 s65, s2, 3
  s_and_b32 s66, s64, 1
  s_lshl_b32 s66, s66, 3
  s_and_b32 s67, s65, 7
  s_add_u32 s55, s66, s67
  s_lshr_b32 s66, s64, 1
  s_lshl_b32 s66, s66, 2
  s_lshr_b32 s67, s65, 3
  s_add_u32 s56, s66, s67
  s_lshl_b32 s60, s55, 4
  s_add_u32 s60, s60, s56
  s_and_b32 s66, s64, 3
  s_lshl_b32 s66, s66, 3
  s_and_b32 s67, s65, 7
  s_add_u32 s61, s66, s67
  s_lshr_b32 s66, s64, 2
  s_lshl_b32 s66, s66, 2
  s_lshr_b32 s67, s65, 3
  s_add_u32 s62, s66, s67
  s_and_b32 s53, s52, 3
  s_lshr_b32 s54, s52, 2
  s_lshl_b32 s63, s60, 3
  s_add_u32 s63, s63, s52
  s_min_u32 s57, s56, 14
  s_lshl_b32 s64, s56, 1
  s_add_u32 s65, s56, 10
  s_cmp_lt_u32 s56, 10
  s_cselect_b32 s58, s64, s65
  s_cselect_b32 s59, 1, 0
  s_cmp_eq_u32 s56, 15
  s_cselect_b32 s59, 1, s59
  s_and_b32 s64, s56, 3
  s_mul_i32 s64, s64, 5
  s_lshr_b32 s64, s64, 1
  s_and_b32 s65, s55, 7
  s_add_u32 s64, s64, s65
  s_cmp_ge_u32 s64, 10
  s_cselect_b32 s65, 10, 0
  s_sub_u32 s75, s64, s65
  s_lshl_b32 s70, s52, 10
  s_lshl_b32 s71, s52, 11
  v_lshrrev_b32 v7, 5, v0
  v_lshrrev_b32 v8, 3, v0
  v_and_b32 v9, 7, v0
  v_lshrrev_b32 v10, 1, v8
  v_xor_b32 v9, v9, v10
  s_lshl_b32 s64, s55, 7
  s_lshl_b32 s65, s52, 4
  s_add_u32 s64, s64, s65
  v_add_u32 v8, s64, v8
  s_movk_i32 s66, 1280
  v_mul_lo_u32 v8, v8, s66
  v_lshl_add_u32 v4, v9, 4, v8
  v_lshrrev_b32 v8, 4, v0
  v_bfe_u32 v9, v0, 2, 2
  v_and_b32 v10, 3, v0
  s_lshl_b32 s64, s52, 3
  v_add_u32 v11, s64, v9
  s_movk_i32 s66, 3840
  v_mul_lo_u32 v11, v11, s66
  v_lshl_add_u32 v11, v8, 6, v11
  v_lshl_add_u32 v11, v10, 4, v11
  s_lshl_b32 s64, s57, 8
  v_add_u32 v5, s64, v11
  v_lshrrev_b32 v11, 1, v8
  v_lshl_add_u32 v11, v11, 2, v9
  s_lshl_b32 s64, s52, 3
  v_add_u32 v11, s64, v11
  s_movk_i32 s66, 3456
  v_mul_lo_u32 v11, v11, s66
  v_lshl_add_u32 v11, v10, 4, v11
  v_and_b32 v2, 1, v8
  v_lshl_add_u32 v2, v2, 6, v11
  s_waitcnt lgkmcnt(0)
  s_mov_b32 s24, s4
  s_and_b32 s25, s5, 0xffff
  s_mov_b32 s26, 2621440
  s_mov_b32 s27, 0x20000
  s_mov_b32 s28, s6
  s_and_b32 s29, s7, 0xffff
  s_mov_b32 s30, 2457600
  s_mov_b32 s31, 0x20000
  s_mov_b32 s32, s12
  s_and_b32 s33, s13, 0xffff
  s_mov_b32 s34, 2211840
  s_mov_b32 s35, 0x20000
  s_mov_b32 s36, s14
  s_and_b32 s37, s15, 0xffff
  s_mov_b32 s38, 2211840
  s_mov_b32 s39, 0x20000
  s_mov_b32 s40, s22
  s_and_b32 s41, s23, 0xffff
  s_mov_b32 s42, 24100864
  s_mov_b32 s43, 0x20000
  s_mov_b32 s48, s22
  s_and_b32 s49, s23, 0xffff
  s_mov_b32 s50, 24100864
  s_mov_b32 s51, 0x20000
  s_mov_b32 s44, s20
  s_and_b32 s45, s21, 0xffff
  s_mov_b32 s46, 256
  s_mov_b32 s47, 0x20000
  s_add_u32 s66, s75, 0
  s_cmp_ge_u32 s66, 10
  s_cselect_b32 s67, 10, 0
  s_sub_u32 s66, s66, s67
  s_add_u32 m0, s71, 133888
  s_lshl_b32 s64, s66, 7
  buffer_load_dwordx4 v4, s[24:27], s64 offen lds
  s_add_u32 s66, s75, 0
  s_cmp_ge_u32 s66, 10
  s_cselect_b32 s67, 10, 0
  s_sub_u32 s66, s66, s67
  s_add_u32 m0, s71, 133888
  s_lshl_b32 s64, s66, 7
  v_xor_b32 v11, 64, v4
  v_add_u32 v11, 9216, v11
  buffer_load_dwordx4 v11, s[24:27], s64 offen offset:1024 lds
  s_add_u32 s66, s75, 0
  s_cmp_ge_u32 s66, 10
  s_cselect_b32 s67, 10, 0
  s_sub_u32 s66, s66, s67
  s_add_u32 m0, s71, 1792
  s_mul_i32 s64, s66, 245760
  buffer_load_dwordx4 v5, s[28:31], s64 offen lds
  s_add_u32 s66, s75, 0
  s_cmp_ge_u32 s66, 10
  s_cselect_b32 s67, 10, 0
  s_sub_u32 s66, s66, s67
  s_add_u32 m0, s71, 1792
  s_mul_i32 s64, s66, 245760
  s_add_u32 s64, s64, 14336
  buffer_load_dwordx4 v5, s[28:31], s64 offen offset:1024 lds
  s_lshl_b32 s64, s55, 7
  s_lshl_b32 s65, s56, 3
  s_add_u32 s64, s64, s65
  s_add_u32 s64, s64, s52
  s_mov_b32 s78, s64
  s_mul_i32 s64, s64, 1280
  v_lshlrev_b32 v8, 4, v0
  v_lshlrev_b32 v9, 2, v0
  buffer_load_dwordx4 v[192:195], v8, s[24:27], s64 offen
  buffer_load_dword v196, v9, s[24:27], s64 offen offset:1024
  v_cmp_le_u32 vcc, 24, v0
  v_mov_b32 v223, 0
  s_nop 0
  v_cndmask_b32 v223, v223, 1, vcc
  v_mul_u32_u24 v222, 24, v223
  v_sub_u32 v222, v0, v222
  v_mov_b32 v224, v222
  s_and_b32 s64, s55, 1
  s_mul_i32 s64, s64, 24
  v_add_u32 v222, s64, v222
  v_lshrrev_b32 v9, 4, v222
  v_bfe_u32 v10, v222, 3, 1
  v_and_b32 v11, 7, v222
  v_mov_b32 v198, s12
  v_mov_b32 v199, s13
  v_cmp_eq_u32 vcc, 1, v10
  v_mov_b32 v200, s14
  v_mov_b32 v201, s15
  v_cndmask_b32 v198, v198, v200, vcc
  v_cndmask_b32 v199, v199, v201, vcc
  v_add_u32 v200, s58, v9
  v_subrev_u32 v200, 1, v200
  v_min_u32 v200, 26, v200
  v_lshlrev_b32 v200, 7, v200
  v_lshl_add_u32 v201, v11, 4, v200
  v_cmp_gt_u32 vcc, 16, v222
  v_mov_b32 v200, s6
  s_nop 0
  v_cndmask_b32 v198, v198, v200, vcc
  v_mov_b32 v200, s7
  v_cndmask_b32 v199, v199, v200, vcc
  s_lshl_b32 s64, s57, 8
  v_lshl_add_u32 v200, v222, 4, s64
  v_cndmask_b32 v201, v201, v200, vcc
  v_mov_b32 v200, 3456
  v_mov_b32 v202, 3840
  v_cndmask_b32 v200, v200, v202, vcc
  s_lshr_b32 s64, s55, 1
  s_mul_i32 s64, s64, 80
  s_mul_i32 s65, s52, 10
  s_add_u32 s64, s64, s65
  v_add_u32 v202, s64, v223
  v_mul_lo_u32 v202, v200, v202
  v_add_u32 v201, v201, v202
  v_add_co_u32 v198, vcc, v198, v201
  s_nop 1
  v_addc_co_u32 v199, vcc, 0, v199, vcc
  v_lshlrev_b32 v200, 1, v200
  s_mov_b64 s[72:73], exec
  s_mov_b32 exec_hi, 0xffff
  global_load_dwordx4 v[228:231], v[198:199], off
  v_add_co_u32 v198, vcc, v198, v200
  s_nop 1
  v_addc_co_u32 v199, vcc, 0, v199, vcc
  global_load_dwordx4 v[232:235], v[198:199], off
  v_add_co_u32 v198, vcc, v198, v200
  s_nop 1
  v_addc_co_u32 v199, vcc, 0, v199, vcc
  global_load_dwordx4 v[236:239], v[198:199], off
  v_add_co_u32 v198, vcc, v198, v200
  s_nop 1
  v_addc_co_u32 v199, vcc, 0, v199, vcc
  global_load_dwordx4 v[240:243], v[198:199], off
  v_add_co_u32 v198, vcc, v198, v200
  s_nop 1
  v_addc_co_u32 v199, vcc, 0, v199, vcc
  global_load_dwordx4 v[244:247], v[198:199], off
  s_mov_b64 exec, s[72:73]
  s_add_u32 s66, s75, 1
  s_cmp_ge_u32 s66, 10
  s_cselect_b32 s67, 10, 0
  s_sub_u32 s66, s66, s67
  s_add_u32 m0, s71, 18304
  s_lshl_b32 s64, s66, 7
  buffer_load_dwordx4 v4, s[24:27], s64 offen lds
  s_add_u32 s66, s75, 1
  s_cmp_ge_u32 s66, 10
  s_cselect_b32 s67, 10, 0
  s_sub_u32 s66, s66, s67
  s_add_u32 m0, s71, 18304
  s_lshl_b32 s64, s66, 7
  v_xor_b32 v11, 64, v4
  v_add_u32 v11, 9216, v11
  buffer_load_dwordx4 v11, s[24:27], s64 offen offset:1024 lds
  s_add_u32 s66, s75, 1
  s_cmp_ge_u32 s66, 10
  s_cselect_b32 s67, 10, 0
  s_sub_u32 s66, s66, s67
  s_add_u32 m0, s71, 34816
  s_mul_i32 s64, s66, 245760
  buffer_load_dwordx4 v5, s[28:31], s64 offen lds
  s_add_u32 s66, s75, 1
  s_cmp_ge_u32 s66, 10
  s_cselect_b32 s67, 10, 0
  s_sub_u32 s66, s66, s67
  s_add_u32 m0, s71, 34816
  s_mul_i32 s64, s66, 245760
  s_add_u32 s64, s64, 14336
  buffer_load_dwordx4 v5, s[28:31], s64 offen offset:1024 lds
  v_lshrrev_b32 v8, 4, v0
  v_bfe_u32 v9, v0, 2, 2
  v_and_b32 v10, 3, v0
  v_and_b32 v11, 1, v8
  v_lshrrev_b32 v8, 1, v8
  v_lshlrev_b32 v12, 6, v9
  v_lshl_add_u32 v12, v10, 3, v12
  v_mul_u32_u24 v1, 8224, v11
  v_lshl_add_u32 v1, v8, 10, v1
  v_add_u32 v1, v1, v12
  s_lshl_b32 s64, s54, 8
  s_add_u32 s64, s64, 1792
  v_add_u32 v1, s64, v1
  v_lshl_add_u32 v12, v8, 11, v12
  v_lshl_add_u32 v12, v11, 5, v12
  s_lshl_b32 s64, s54, 9
  s_add_u32 s64, s64, 1792
  v_add_u32 v3, s64, v12
  v_and_b32 v8, 31, v0
  s_lshl_b32 s64, s53, 5
  v_add_u32 v8, s64, v8
  v_bfe_u32 v9, v8, 1, 3
  v_xor_b32 v9, v9, v7
  v_lshlrev_b32 v9, 4, v9
  v_lshl_add_u32 v6, v8, 7, v9
  v_add_u32 v6, 133888, v6
  s_waitcnt vmcnt(11)
  s_barrier
  ds_read_b128 v[96:99], v6
  ds_read_b64_tr_b16 v[16:17], v3 offset:0
  ds_read_b64_tr_b16 v[18:19], v3 offset:1024
  ds_read_b64_tr_b16 v[20:21], v3 offset:256
  ds_read_b64_tr_b16 v[22:23], v3 offset:1280
  v_xor_b32 v11, 32, v6
  ds_read_b128 v[100:103], v11
  ds_read_b64_tr_b16 v[24:25], v3 offset:4096
  ds_read_b64_tr_b16 v[26:27], v3 offset:5120
  ds_read_b64_tr_b16 v[28:29], v3 offset:4352
  ds_read_b64_tr_b16 v[30:31], v3 offset:5376
  s_waitcnt lgkmcnt(5)
  v_mfma_f32_32x32x16_bf16 v[32:47], v[16:19], v[96:99], 0
  s_waitcnt vmcnt(9)
  v_lshlrev_b32 v202, 16, v192
  v_and_b32 v203, 0xffff0000, v192
  v_lshlrev_b32 v204, 16, v193
  v_and_b32 v205, 0xffff0000, v193
  v_mfma_f32_32x32x16_bf16 v[48:63], v[20:23], v[96:99], 0
  s_add_u32 s66, s75, 2
  s_cmp_ge_u32 s66, 10
  s_cselect_b32 s67, 10, 0
  s_sub_u32 s66, s66, s67
  s_add_u32 m0, s71, 51328
  s_lshl_b32 s64, s66, 7
  buffer_load_dwordx4 v4, s[24:27], s64 offen lds
  s_add_u32 s66, s75, 2
  s_cmp_ge_u32 s66, 10
  s_cselect_b32 s67, 10, 0
  s_sub_u32 s66, s66, s67
  s_add_u32 m0, s71, 51328
  s_lshl_b32 s64, s66, 7
  v_xor_b32 v11, 64, v4
  v_add_u32 v11, 9216, v11
  buffer_load_dwordx4 v11, s[24:27], s64 offen offset:1024 lds
  v_xor_b32 v11, 64, v6
  ds_read_b128 v[104:107], v11
  ds_read_b64_tr_b16 v[16:17], v3 offset:8192
  ds_read_b64_tr_b16 v[18:19], v3 offset:9216
  ds_read_b64_tr_b16 v[20:21], v3 offset:8448
  ds_read_b64_tr_b16 v[22:23], v3 offset:9472
  v_lshlrev_b32 v206, 16, v194
  v_and_b32 v207, 0xffff0000, v194
  v_lshlrev_b32 v208, 16, v195
  v_and_b32 v209, 0xffff0000, v195
  v_lshlrev_b32 v210, 16, v196
  s_waitcnt lgkmcnt(5)
  v_mfma_f32_32x32x16_bf16 v[32:47], v[24:27], v[100:103], v[32:47]
  v_and_b32 v211, 0xffff0000, v196
  v_add_f32 v192, v202, v203
  v_add_f32 v192, v192, v204
  v_add_f32 v192, v192, v205
  v_add_f32 v192, v192, v206
  v_mfma_f32_32x32x16_bf16 v[48:63], v[28:31], v[100:103], v[48:63]
  s_add_u32 s66, s75, 2
  s_cmp_ge_u32 s66, 10
  s_cselect_b32 s67, 10, 0
  s_sub_u32 s66, s66, s67
  s_add_u32 m0, s71, 67840
  s_mul_i32 s64, s66, 245760
  buffer_load_dwordx4 v5, s[28:31], s64 offen lds
  s_add_u32 s66, s75, 2
  s_cmp_ge_u32 s66, 10
  s_cselect_b32 s67, 10, 0
  s_sub_u32 s66, s66, s67
  s_add_u32 m0, s71, 67840
  s_mul_i32 s64, s66, 245760
  s_add_u32 s64, s64, 14336
  buffer_load_dwordx4 v5, s[28:31], s64 offen offset:1024 lds
  v_xor_b32 v11, 96, v6
  ds_read_b128 v[108:111], v11
  ds_read_b64_tr_b16 v[24:25], v3 offset:12288
  ds_read_b64_tr_b16 v[26:27], v3 offset:13312
  ds_read_b64_tr_b16 v[28:29], v3 offset:12544
  ds_read_b64_tr_b16 v[30:31], v3 offset:13568
  v_add_f32 v192, v192, v207
  v_add_f32 v192, v192, v208
  v_add_f32 v192, v192, v209
  v_add_f32 v192, v192, v210
  v_add_f32 v192, v192, v211
  s_waitcnt lgkmcnt(5)
  v_mfma_f32_32x32x16_bf16 v[32:47], v[16:19], v[104:107], v[32:47]
  v_add_f32_dpp v192, v192, v192 row_shr:1 row_mask:0xf bank_mask:0xf bound_ctrl:0
  s_nop 1
  v_add_f32_dpp v192, v192, v192 row_shr:2 row_mask:0xf bank_mask:0xf bound_ctrl:0
  s_nop 1
  v_add_f32_dpp v192, v192, v192 row_shr:4 row_mask:0xf bank_mask:0xf bound_ctrl:0
  s_nop 1
  v_add_f32_dpp v192, v192, v192 row_shr:8 row_mask:0xf bank_mask:0xf bound_ctrl:0
  s_nop 1
  v_add_f32_dpp v192, v192, v192 row_bcast:15 row_mask:0xa bank_mask:0xf
  v_mfma_f32_32x32x16_bf16 v[48:63], v[20:23], v[104:107], v[48:63]
  s_add_u32 s66, s75, 3
  s_cmp_ge_u32 s66, 10
  s_cselect_b32 s67, 10, 0
  s_sub_u32 s66, s66, s67
  s_add_u32 m0, s71, 84352
  s_lshl_b32 s64, s66, 7
  buffer_load_dwordx4 v4, s[24:27], s64 offen lds
  s_add_u32 s66, s75, 3
  s_cmp_ge_u32 s66, 10
  s_cselect_b32 s67, 10, 0
  s_sub_u32 s66, s66, s67
  s_add_u32 m0, s71, 84352
  s_lshl_b32 s64, s66, 7
  v_xor_b32 v11, 64, v4
  v_add_u32 v11, 9216, v11
  buffer_load_dwordx4 v11, s[24:27], s64 offen offset:1024 lds
  s_waitcnt vmcnt(6)
  s_waitcnt lgkmcnt(0)
  s_barrier
  v_add_u32 v6, 0xfffe3c80, v6
  v_add_u32 v3, 0x8100, v3
  ds_read_b128 v[112:115], v6
  ds_read_b64_tr_b16 v[16:17], v3 offset:0
  ds_read_b64_tr_b16 v[18:19], v3 offset:1024
  ds_read_b64_tr_b16 v[20:21], v3 offset:256
  ds_read_b64_tr_b16 v[22:23], v3 offset:1280
  v_add_f32_dpp v192, v192, v192 row_bcast:31 row_mask:0xc bank_mask:0xf
  s_nop 0
  v_readlane_b32 s66, v192, 63
  s_nop 1
  v_mov_b32 v193, s66
  v_mul_f32 v193, 0x3acccccd, v193
  v_sub_f32 v202, v202, v193
  v_mfma_f32_32x32x16_bf16 v[32:47], v[24:27], v[108:111], v[32:47]
  v_sub_f32 v203, v203, v193
  v_sub_f32 v204, v204, v193
  v_sub_f32 v205, v205, v193
  v_sub_f32 v206, v206, v193
  v_sub_f32 v207, v207, v193
  v_mfma_f32_32x32x16_bf16 v[48:63], v[28:31], v[108:111], v[48:63]
  s_add_u32 s66, s75, 3
  s_cmp_ge_u32 s66, 10
  s_cselect_b32 s67, 10, 0
  s_sub_u32 s66, s66, s67
  s_add_u32 m0, s71, 100864
  s_mul_i32 s64, s66, 245760
  buffer_load_dwordx4 v5, s[28:31], s64 offen lds
  s_add_u32 s66, s75, 3
  s_cmp_ge_u32 s66, 10
  s_cselect_b32 s67, 10, 0
  s_sub_u32 s66, s66, s67
  s_add_u32 m0, s71, 100864
  s_mul_i32 s64, s66, 245760
  s_add_u32 s64, s64, 14336
  buffer_load_dwordx4 v5, s[28:31], s64 offen offset:1024 lds
  v_xor_b32 v11, 32, v6
  ds_read_b128 v[116:119], v11
  ds_read_b64_tr_b16 v[24:25], v3 offset:4096
  ds_read_b64_tr_b16 v[26:27], v3 offset:5120
  ds_read_b64_tr_b16 v[28:29], v3 offset:4352
  ds_read_b64_tr_b16 v[30:31], v3 offset:5376
  v_sub_f32 v208, v208, v193
  v_sub_f32 v209, v209, v193
  v_sub_f32 v210, v210, v193
  v_sub_f32 v211, v211, v193
  v_mul_f32 v192, v202, v202
  s_waitcnt lgkmcnt(5)
  v_mfma_f32_32x32x16_bf16 v[32:47], v[16:19], v[112:115], v[32:47]
  v_fma_f32 v192, v203, v203, v192
  v_fma_f32 v192, v204, v204, v192
  v_fma_f32 v192, v205, v205, v192
  v_fma_f32 v192, v206, v206, v192
  v_fma_f32 v192, v207, v207, v192
  v_mfma_f32_32x32x16_bf16 v[48:63], v[20:23], v[112:115], v[48:63]
  s_add_u32 s66, s75, 4
  s_cmp_ge_u32 s66, 10
  s_cselect_b32 s67, 10, 0
  s_sub_u32 s66, s66, s67
  s_add_u32 m0, s71, 117376
  s_lshl_b32 s64, s66, 7
  buffer_load_dwordx4 v4, s[24:27], s64 offen lds
  s_add_u32 s66, s75, 4
  s_cmp_ge_u32 s66, 10
  s_cselect_b32 s67, 10, 0
  s_sub_u32 s66, s66, s67
  s_add_u32 m0, s71, 117376
  s_lshl_b32 s64, s66, 7
  v_xor_b32 v11, 64, v4
  v_add_u32 v11, 9216, v11
  buffer_load_dwordx4 v11, s[24:27], s64 offen offset:1024 lds
  v_xor_b32 v11, 64, v6
  ds_read_b128 v[120:123], v11
  ds_read_b64_tr_b16 v[16:17], v3 offset:8192
  ds_read_b64_tr_b16 v[18:19], v3 offset:9216
  ds_read_b64_tr_b16 v[20:21], v3 offset:8448
  ds_read_b64_tr_b16 v[22:23], v3 offset:9472
  v_fma_f32 v192, v208, v208, v192
  v_fma_f32 v192, v209, v209, v192
  v_fma_f32 v192, v210, v210, v192
  v_fma_f32 v192, v211, v211, v192
  s_nop 1
  v_add_f32_dpp v192, v192, v192 row_shr:1 row_mask:0xf bank_mask:0xf bound_ctrl:0
  s_waitcnt lgkmcnt(5)
  v_mfma_f32_32x32x16_bf16 v[32:47], v[24:27], v[116:119], v[32:47]
  v_add_f32_dpp v192, v192, v192 row_shr:2 row_mask:0xf bank_mask:0xf bound_ctrl:0
  s_nop 1
  v_add_f32_dpp v192, v192, v192 row_shr:4 row_mask:0xf bank_mask:0xf bound_ctrl:0
  s_nop 1
  v_add_f32_dpp v192, v192, v192 row_shr:8 row_mask:0xf bank_mask:0xf bound_ctrl:0
  s_nop 1
  v_add_f32_dpp v192, v192, v192 row_bcast:15 row_mask:0xa bank_mask:0xf
  s_nop 1
  v_add_f32_dpp v192, v192, v192 row_bcast:31 row_mask:0xc bank_mask:0xf
  v_mfma_f32_32x32x16_bf16 v[48:63], v[28:31], v[116:119], v[48:63]
  s_add_u32 s66, s75, 4
  s_cmp_ge_u32 s66, 10
  s_cselect_b32 s67, 10, 0
  s_sub_u32 s66, s66, s67
  s_add_u32 m0, s71, 133888
  s_mul_i32 s64, s66, 245760
  buffer_load_dwordx4 v5, s[28:31], s64 offen lds
  s_add_u32 s66, s75, 4
  s_cmp_ge_u32 s66, 10
  s_cselect_b32 s67, 10, 0
  s_sub_u32 s66, s66, s67
  s_add_u32 m0, s71, 133888
  s_mul_i32 s64, s66, 245760
  s_add_u32 s64, s64, 14336
  buffer_load_dwordx4 v5, s[28:31], s64 offen offset:1024 lds
  v_xor_b32 v11, 96, v6
  ds_read_b128 v[124:127], v11
  ds_read_b64_tr_b16 v[24:25], v3 offset:12288
  ds_read_b64_tr_b16 v[26:27], v3 offset:13312
  ds_read_b64_tr_b16 v[28:29], v3 offset:12544
  ds_read_b64_tr_b16 v[30:31], v3 offset:13568
  v_readlane_b32 s66, v192, 63
  s_nop 1
  v_mov_b32 v194, s66
  v_mul_f32 v194, 0x3acccccd, v194
  v_add_f32 v194, 0x3727c5ac, v194
  v_rsq_f32 v194, v194
  s_waitcnt lgkmcnt(5)
  v_mfma_f32_32x32x16_bf16 v[32:47], v[16:19], v[120:123], v[32:47]
  s_lshl_b32 s64, s52, 4
  s_add_u32 s64, s64, 1536
  v_mov_b32 v192, s64
  v_mov_b32 v196, v193
  v_mov_b32 v197, v194
  v_mfma_f32_32x32x16_bf16 v[48:63], v[20:23], v[120:123], v[48:63]
  s_add_u32 s66, s75, 0
  s_cmp_ge_u32 s66, 10
  s_cselect_b32 s67, 10, 0
  s_sub_u32 s66, s66, s67
  s_mul_i32 s66, s66, 221184
  s_lshl_b32 s64, s58, 7
  s_add_u32 s64, s64, s66
  s_add_u32 m0, s70, 1792
  s_nop 0
  buffer_load_dwordx4 v2, s[32:35], s64 offen lds
  s_add_u32 s66, s75, 0
  s_cmp_ge_u32 s66, 10
  s_cselect_b32 s67, 10, 0
  s_sub_u32 s66, s66, s67
  s_mul_i32 s66, s66, 221184
  s_lshl_b32 s64, s58, 7
  s_add_u32 s64, s64, s66
  s_add_u32 m0, s70, 10016
  s_nop 0
  buffer_load_dwordx4 v2, s[36:39], s64 offen lds
  s_waitcnt vmcnt(10)
  v_mov_b32 v198, 0
  v_mov_b32 v199, 0
  s_mov_b64 exec, 1
  ds_write_b128 v192, v[196:199]
  s_mov_b64 exec, -1
  v_lshlrev_b32 v202, 16, v228
  v_and_b32 v203, 0xffff0000, v228
  v_lshlrev_b32 v204, 16, v229
  v_and_b32 v205, 0xffff0000, v229
  v_lshlrev_b32 v206, 16, v230
  v_and_b32 v207, 0xffff0000, v230
  v_lshlrev_b32 v208, 16, v231
  v_and_b32 v209, 0xffff0000, v231
  v_lshlrev_b32 v212, 16, v232
  v_and_b32 v213, 0xffff0000, v232
  v_lshlrev_b32 v214, 16, v233
  v_and_b32 v215, 0xffff0000, v233
  v_lshlrev_b32 v216, 16, v234
  v_and_b32 v217, 0xffff0000, v234
  v_lshlrev_b32 v218, 16, v235
  v_and_b32 v219, 0xffff0000, v235
  v_add_f32 v202, v202, v212
  v_add_f32 v203, v203, v213
  v_add_f32 v204, v204, v214
  v_add_f32 v205, v205, v215
  v_add_f32 v206, v206, v216
  v_add_f32 v207, v207, v217
  v_add_f32 v208, v208, v218
  v_add_f32 v209, v209, v219
  v_lshlrev_b32 v212, 16, v236
  v_and_b32 v213, 0xffff0000, v236
  v_lshlrev_b32 v214, 16, v237
  v_and_b32 v215, 0xffff0000, v237
  v_lshlrev_b32 v216, 16, v238
  v_and_b32 v217, 0xffff0000, v238
  v_lshlrev_b32 v218, 16, v239
  v_and_b32 v219, 0xffff0000, v239
  v_add_f32 v202, v202, v212
  v_add_f32 v203, v203, v213
  v_add_f32 v204, v204, v214
  v_add_f32 v205, v205, v215
  v_add_f32 v206, v206, v216
  v_add_f32 v207, v207, v217
  v_add_f32 v208, v208, v218
  v_add_f32 v209, v209, v219
  v_lshlrev_b32 v212, 16, v240
  v_and_b32 v213, 0xffff0000, v240
  v_lshlrev_b32 v214, 16, v241
  v_and_b32 v215, 0xffff0000, v241
  v_lshlrev_b32 v216, 16, v242
  v_and_b32 v217, 0xffff0000, v242
  v_lshlrev_b32 v218, 16, v243
  v_and_b32 v219, 0xffff0000, v243
  v_add_f32 v202, v202, v212
  v_add_f32 v203, v203, v213
  v_add_f32 v204, v204, v214
  v_add_f32 v205, v205, v215
  v_add_f32 v206, v206, v216
  v_add_f32 v207, v207, v217
  v_add_f32 v208, v208, v218
  v_add_f32 v209, v209, v219
  v_lshlrev_b32 v212, 16, v244
  v_and_b32 v213, 0xffff0000, v244
  v_lshlrev_b32 v214, 16, v245
  v_and_b32 v215, 0xffff0000, v245
  v_lshlrev_b32 v216, 16, v246
  v_and_b32 v217, 0xffff0000, v246
  v_lshlrev_b32 v218, 16, v247
  v_and_b32 v219, 0xffff0000, v247
  v_add_f32 v202, v202, v212
  v_add_f32 v203, v203, v213
  v_add_f32 v204, v204, v214
  v_add_f32 v205, v205, v215
  v_add_f32 v206, v206, v216
  v_add_f32 v207, v207, v217
  v_add_f32 v208, v208, v218
  v_add_f32 v209, v209, v219
  v_lshlrev_b32 v192, 5, v224
  v_mul_u32_u24 v193, 768, v223
  v_add_u32 v192, v192, v193
  s_mul_i32 s64, s52, 1536
  s_add_u32 s64, s64, 150400
  v_add_u32 v192, s64, v192
  s_mov_b32 exec_hi, 0xffff
  ds_write_b128 v192, v[202:205]
  ds_write_b128 v192, v[206:209] offset:16
  s_mov_b64 exec, -1
  s_waitcnt lgkmcnt(0)
  s_barrier
  v_add_u32 v6, 0x8100, v6
  v_add_u32 v3, 0x8100, v3
  ds_read_b128 v[128:131], v6
  ds_read_b64_tr_b16 v[16:17], v3 offset:0
  ds_read_b64_tr_b16 v[18:19], v3 offset:1024
  ds_read_b64_tr_b16 v[20:21], v3 offset:256
  ds_read_b64_tr_b16 v[22:23], v3 offset:1280
  v_lshlrev_b32 v192, 2, v0
  s_min_u32 s64, s52, 2
  s_lshl_b32 s64, s64, 8
  v_add_u32 v192, s64, v192
  v_add_u32 v194, 150400, v192
  v_mfma_f32_32x32x16_bf16 v[32:47], v[24:27], v[124:127], v[32:47]
  ds_read_b32 v202, v194 offset:0
  ds_read_b32 v203, v194 offset:768
  ds_read_b32 v204, v194 offset:1536
  ds_read_b32 v205, v194 offset:2304
  ds_read_b32 v206, v194 offset:3072
  v_mfma_f32_32x32x16_bf16 v[48:63], v[28:31], v[124:127], v[48:63]
  s_add_u32 s66, s75, 5
  s_cmp_ge_u32 s66, 10
  s_cselect_b32 s67, 10, 0
  s_sub_u32 s66, s66, s67
  s_add_u32 m0, s71, 18304
  s_lshl_b32 s64, s66, 7
  buffer_load_dwordx4 v4, s[24:27], s64 offen lds
  s_add_u32 s66, s75, 5
  s_cmp_ge_u32 s66, 10
  s_cselect_b32 s67, 10, 0
  s_sub_u32 s66, s66, s67
  s_add_u32 m0, s71, 18304
  s_lshl_b32 s64, s66, 7
  v_xor_b32 v11, 64, v4
  v_add_u32 v11, 9216, v11
  buffer_load_dwordx4 v11, s[24:27], s64 offen offset:1024 lds
  v_xor_b32 v11, 32, v6
  ds_read_b128 v[132:135], v11
  ds_read_b64_tr_b16 v[24:25], v3 offset:4096
  ds_read_b64_tr_b16 v[26:27], v3 offset:5120
  ds_read_b64_tr_b16 v[28:29], v3 offset:4352
  ds_read_b64_tr_b16 v[30:31], v3 offset:5376
  ds_read_b32 v207, v194 offset:3840
  ds_read_b32 v208, v194 offset:4608
  ds_read_b32 v209, v194 offset:5376
  ds_read_b32 v210, v194 offset:6144
  ds_read_b32 v211, v194 offset:6912
  s_waitcnt lgkmcnt(15)
  v_mfma_f32_32x32x16_bf16 v[32:47], v[16:19], v[128:131], v[32:47]
  ds_read_b32 v212, v194 offset:7680
  ds_read_b32 v213, v194 offset:8448
  ds_read_b32 v214, v194 offset:9216
  ds_read_b32 v215, v194 offset:9984
  ds_read_b32 v216, v194 offset:10752
  v_mfma_f32_32x32x16_bf16 v[48:63], v[20:23], v[128:131], v[48:63]
  s_add_u32 s66, s75, 5
  s_cmp_ge_u32 s66, 10
  s_cselect_b32 s67, 10, 0
  s_sub_u32 s66, s66, s67
  s_add_u32 m0, s71, 34816
  s_mul_i32 s64, s66, 245760
  buffer_load_dwordx4 v5, s[28:31], s64 offen lds
  s_add_u32 s66, s75, 5
  s_cmp_ge_u32 s66, 10
  s_cselect_b32 s67, 10, 0
  s_sub_u32 s66, s66, s67
  s_add_u32 m0, s71, 34816
  s_mul_i32 s64, s66, 245760
  s_add_u32 s64, s64, 14336
  buffer_load_dwordx4 v5, s[28:31], s64 offen offset:1024 lds
  v_xor_b32 v11, 64, v6
  ds_read_b128 v[136:139], v11
  ds_read_b64_tr_b16 v[16:17], v3 offset:8192
  ds_read_b64_tr_b16 v[18:19], v3 offset:9216
  ds_read_b64_tr_b16 v[20:21], v3 offset:8448
  ds_read_b64_tr_b16 v[22:23], v3 offset:9472
  ds_read_b32 v217, v194 offset:11520
  s_lshl_b32 s64, s56, 3
  s_lshr_b32 s65, s55, 1
  s_add_u32 s64, s64, s65
  s_mul_i32 s64, s64, 1536
  s_and_b32 s65, s55, 1
  s_mul_i32 s65, s65, 768
  s_add_u32 s64, s64, s65
  s_add_u32 s64, s64, 23871488
  s_waitcnt lgkmcnt(0)
  v_add_f32 v193, v202, v203
  v_add_f32 v193, v193, v204
  v_add_f32 v193, v193, v205
  v_add_f32 v193, v193, v206
  v_add_f32 v193, v193, v207
  v_add_f32 v193, v193, v208
  v_add_f32 v193, v193, v209
  v_add_f32 v193, v193, v210
  v_add_f32 v193, v193, v211
  v_add_f32 v193, v193, v212
  v_add_f32 v193, v193, v213
  v_add_f32 v193, v193, v214
  v_add_f32 v193, v193, v215
  v_add_f32 v193, v193, v216
  v_add_f32 v193, v193, v217
  buffer_store_dword v193, v192, s[40:43], s64 offen sc1
  v_mfma_f32_32x32x16_bf16 v[32:47], v[24:27], v[132:135], v[32:47]
  v_lshlrev_b32 v194, 4, v0
  s_mov_b64 exec, 0xff
  ds_read_b128 v[220:223], v194 offset:1536
  v_mov_b32 v216, 0
  v_mov_b32 v217, 0
  v_mov_b32 v218, 0
  v_mov_b32 v219, 0
  s_lshl_b32 s64, s55, 7
  s_lshl_b32 s65, s56, 3
  s_add_u32 s64, s64, s65
  s_lshl_b32 s64, s64, 4
  s_add_u32 s64, s64, 23838720
  s_lshl_b32 s65, s60, 7
  s_add_u32 s65, s65, 24068096
  s_waitcnt lgkmcnt(0)
  buffer_store_dwordx4 v[220:223], v194, s[40:43], s64 offen sc1
  buffer_store_dwordx4 v[216:219], v194, s[40:43], s65 offen sc1
  s_mov_b64 exec, -1
  v_mfma_f32_32x32x16_bf16 v[48:63], v[28:31], v[132:135], v[48:63]
  v_xor_b32 v11, 96, v6
  ds_read_b128 v[140:143], v11
  ds_read_b64_tr_b16 v[24:25], v3 offset:12288
  ds_read_b64_tr_b16 v[26:27], v3 offset:13312
  ds_read_b64_tr_b16 v[28:29], v3 offset:12544
  ds_read_b64_tr_b16 v[30:31], v3 offset:13568
  v_mfma_f32_32x32x16_bf16 v[32:47], v[16:19], v[136:139], v[32:47]
  v_mfma_f32_32x32x16_bf16 v[48:63], v[20:23], v[136:139], v[48:63]
  s_waitcnt vmcnt(13)
  s_waitcnt lgkmcnt(0)
  s_barrier
  v_add_u32 v6, 0x8100, v6
  v_add_u32 v3, 0x8100, v3
  ds_read_b128 v[144:147], v6
  ds_read_b64_tr_b16 v[16:17], v3 offset:0
  ds_read_b64_tr_b16 v[18:19], v3 offset:1024
  ds_read_b64_tr_b16 v[20:21], v3 offset:256
  ds_read_b64_tr_b16 v[22:23], v3 offset:1280
  v_mfma_f32_32x32x16_bf16 v[32:47], v[24:27], v[140:143], v[32:47]
  v_mfma_f32_32x32x16_bf16 v[48:63], v[28:31], v[140:143], v[48:63]
  s_add_u32 s66, s75, 1
  s_cmp_ge_u32 s66, 10
  s_cselect_b32 s67, 10, 0
  s_sub_u32 s66, s66, s67
  s_mul_i32 s66, s66, 221184
  s_lshl_b32 s64, s58, 7
  s_add_u32 s64, s64, s66
  s_add_u32 m0, s70, 51328
  s_nop 0
  buffer_load_dwordx4 v2, s[32:35], s64 offen lds
  s_add_u32 s66, s75, 1
  s_cmp_ge_u32 s66, 10
  s_cselect_b32 s67, 10, 0
  s_sub_u32 s66, s66, s67
  s_mul_i32 s66, s66, 221184
  s_lshl_b32 s64, s58, 7
  s_add_u32 s64, s64, s66
  s_add_u32 m0, s70, 59552
  s_nop 0
  buffer_load_dwordx4 v2, s[36:39], s64 offen lds
  v_xor_b32 v11, 32, v6
  ds_read_b128 v[148:151], v11
  ds_read_b64_tr_b16 v[24:25], v3 offset:4096
  ds_read_b64_tr_b16 v[26:27], v3 offset:5120
  ds_read_b64_tr_b16 v[28:29], v3 offset:4352
  ds_read_b64_tr_b16 v[30:31], v3 offset:5376
  s_waitcnt lgkmcnt(5)
  v_mfma_f32_32x32x16_bf16 v[32:47], v[16:19], v[144:147], v[32:47]
  v_mfma_f32_32x32x16_bf16 v[48:63], v[20:23], v[144:147], v[48:63]
  s_add_u32 s66, s75, 6
  s_cmp_ge_u32 s66, 10
  s_cselect_b32 s67, 10, 0
  s_sub_u32 s66, s66, s67
  s_add_u32 m0, s71, 67840
  s_lshl_b32 s64, s66, 7
  buffer_load_dwordx4 v4, s[24:27], s64 offen lds
  s_add_u32 s66, s75, 6
  s_cmp_ge_u32 s66, 10
  s_cselect_b32 s67, 10, 0
  s_sub_u32 s66, s66, s67
  s_add_u32 m0, s71, 67840
  s_lshl_b32 s64, s66, 7
  v_xor_b32 v11, 64, v4
  v_add_u32 v11, 9216, v11
  buffer_load_dwordx4 v11, s[24:27], s64 offen offset:1024 lds
  v_xor_b32 v11, 64, v6
  ds_read_b128 v[152:155], v11
  ds_read_b64_tr_b16 v[16:17], v3 offset:8192
  ds_read_b64_tr_b16 v[18:19], v3 offset:9216
  ds_read_b64_tr_b16 v[20:21], v3 offset:8448
  ds_read_b64_tr_b16 v[22:23], v3 offset:9472
  s_waitcnt lgkmcnt(5)
  v_mfma_f32_32x32x16_bf16 v[32:47], v[24:27], v[148:151], v[32:47]
  v_mfma_f32_32x32x16_bf16 v[48:63], v[28:31], v[148:151], v[48:63]
  v_xor_b32 v11, 96, v6
  ds_read_b128 v[156:159], v11
  ds_read_b64_tr_b16 v[24:25], v3 offset:12288
  ds_read_b64_tr_b16 v[26:27], v3 offset:13312
  ds_read_b64_tr_b16 v[28:29], v3 offset:12544
  ds_read_b64_tr_b16 v[30:31], v3 offset:13568
  s_waitcnt lgkmcnt(5)
  v_mfma_f32_32x32x16_bf16 v[32:47], v[16:19], v[152:155], v[32:47]
  v_mfma_f32_32x32x16_bf16 v[48:63], v[20:23], v[152:155], v[48:63]
  s_waitcnt vmcnt(11)
  s_waitcnt vmcnt(4)
  s_waitcnt lgkmcnt(0)
  s_barrier
  s_cmp_eq_u32 s52, 0
  s_cbranch_scc0 L_s0a_816
  s_and_b32 s64, s60, 3
  s_lshl_b32 s64, s64, 6
  v_mov_b32 v10, 1
  v_mov_b32 v11, s64
  s_mov_b64 s[72:73], exec
  s_mov_b64 exec, 1
  buffer_atomic_add v10, v11, s[44:47], 0 offen sc1
  s_mov_b64 exec, s[72:73]
L_s0a_816:
  v_add_u32 v6, 0x8100, v6
  v_add_u32 v3, 0x8100, v3
  ds_read_b128 v[160:163], v6
  ds_read_b64_tr_b16 v[16:17], v3 offset:0
  ds_read_b64_tr_b16 v[18:19], v3 offset:1024
  ds_read_b64_tr_b16 v[20:21], v3 offset:256
  ds_read_b64_tr_b16 v[22:23], v3 offset:1280
  v_mfma_f32_32x32x16_bf16 v[32:47], v[24:27], v[156:159], v[32:47]
  v_mfma_f32_32x32x16_bf16 v[48:63], v[28:31], v[156:159], v[48:63]
  s_add_u32 s66, s75, 6
  s_cmp_ge_u32 s66, 10
  s_cselect_b32 s67, 10, 0
  s_sub_u32 s66, s66, s67
  s_add_u32 m0, s71, 84352
  s_mul_i32 s64, s66, 245760
  buffer_load_dwordx4 v5, s[28:31], s64 offen lds
  s_add_u32 s66, s75, 6
  s_cmp_ge_u32 s66, 10
  s_cselect_b32 s67, 10, 0
  s_sub_u32 s66, s66, s67
  s_add_u32 m0, s71, 84352
  s_mul_i32 s64, s66, 245760
  s_add_u32 s64, s64, 14336
  buffer_load_dwordx4 v5, s[28:31], s64 offen offset:1024 lds
  ds_read_b64_tr_b16 v[24:25], v1 offset:0
  ds_read_b64_tr_b16 v[26:27], v1 offset:512
  ds_read_b64_tr_b16 v[28:29], v1 offset:32
  ds_read_b64_tr_b16 v[30:31], v1 offset:544
  s_waitcnt lgkmcnt(4)
  v_mfma_f32_32x32x16_bf16 v[32:47], v[16:19], v[160:163], v[32:47]
  v_mfma_f32_32x32x16_bf16 v[48:63], v[20:23], v[160:163], v[48:63]
  s_add_u32 s66, s75, 2
  s_cmp_ge_u32 s66, 10
  s_cselect_b32 s67, 10, 0
  s_sub_u32 s66, s66, s67
  s_mul_i32 s66, s66, 221184
  s_lshl_b32 s64, s58, 7
  s_add_u32 s64, s64, s66
  s_add_u32 m0, s70, 100864
  s_nop 0
  buffer_load_dwordx4 v2, s[32:35], s64 offen lds
  s_add_u32 s66, s75, 2
  s_cmp_ge_u32 s66, 10
  s_cselect_b32 s67, 10, 0
  s_sub_u32 s66, s66, s67
  s_mul_i32 s66, s66, 221184
  s_lshl_b32 s64, s58, 7
  s_add_u32 s64, s64, s66
  s_add_u32 m0, s70, 109088
  s_nop 0
  buffer_load_dwordx4 v2, s[36:39], s64 offen lds
  v_xor_b32 v11, 32, v6
  ds_read_b128 v[164:167], v11
  ds_read_b64_tr_b16 v[16:17], v3 offset:4096
  ds_read_b64_tr_b16 v[18:19], v3 offset:5120
  ds_read_b64_tr_b16 v[20:21], v3 offset:4352
  ds_read_b64_tr_b16 v[22:23], v3 offset:5376
  s_waitcnt lgkmcnt(5)
  v_mfma_f32_32x32x16_bf16 v[64:79], v[24:27], v[96:99], 0
  v_mfma_f32_32x32x16_bf16 v[80:95], v[28:31], v[96:99], 0
  ds_read_b64_tr_b16 v[24:25], v1 offset:2048
  ds_read_b64_tr_b16 v[26:27], v1 offset:2560
  ds_read_b64_tr_b16 v[28:29], v1 offset:2080
  ds_read_b64_tr_b16 v[30:31], v1 offset:2592
  s_waitcnt lgkmcnt(4)
  v_mfma_f32_32x32x16_bf16 v[32:47], v[16:19], v[164:167], v[32:47]
  v_mfma_f32_32x32x16_bf16 v[48:63], v[20:23], v[164:167], v[48:63]
  v_xor_b32 v11, 64, v6
  ds_read_b128 v[168:171], v11
  ds_read_b64_tr_b16 v[16:17], v3 offset:8192
  ds_read_b64_tr_b16 v[18:19], v3 offset:9216
  ds_read_b64_tr_b16 v[20:21], v3 offset:8448
  ds_read_b64_tr_b16 v[22:23], v3 offset:9472
  s_waitcnt lgkmcnt(5)
  v_mfma_f32_32x32x16_bf16 v[64:79], v[24:27], v[100:103], v[64:79]
  v_mfma_f32_32x32x16_bf16 v[80:95], v[28:31], v[100:103], v[80:95]
  ds_read_b64_tr_b16 v[24:25], v1 offset:4096
  ds_read_b64_tr_b16 v[26:27], v1 offset:4608
  ds_read_b64_tr_b16 v[28:29], v1 offset:4128
  ds_read_b64_tr_b16 v[30:31], v1 offset:4640
  s_waitcnt lgkmcnt(4)
  v_mfma_f32_32x32x16_bf16 v[32:47], v[16:19], v[168:171], v[32:47]
  v_mfma_f32_32x32x16_bf16 v[48:63], v[20:23], v[168:171], v[48:63]
  v_xor_b32 v11, 96, v6
  ds_read_b128 v[172:175], v11
  ds_read_b64_tr_b16 v[16:17], v3 offset:12288
  ds_read_b64_tr_b16 v[18:19], v3 offset:13312
  ds_read_b64_tr_b16 v[20:21], v3 offset:12544
  ds_read_b64_tr_b16 v[22:23], v3 offset:13568
  s_waitcnt lgkmcnt(5)
  v_mfma_f32_32x32x16_bf16 v[64:79], v[24:27], v[104:107], v[64:79]
  v_mfma_f32_32x32x16_bf16 v[80:95], v[28:31], v[104:107], v[80:95]
  ds_read_b64_tr_b16 v[24:25], v1 offset:6144
  ds_read_b64_tr_b16 v[26:27], v1 offset:6656
  ds_read_b64_tr_b16 v[28:29], v1 offset:6176
  ds_read_b64_tr_b16 v[30:31], v1 offset:6688
  s_waitcnt lgkmcnt(4)
  v_mfma_f32_32x32x16_bf16 v[32:47], v[16:19], v[172:175], v[32:47]
  v_mfma_f32_32x32x16_bf16 v[48:63], v[20:23], v[172:175], v[48:63]
  s_waitcnt vmcnt(6)
  s_waitcnt lgkmcnt(0)
  s_barrier
  v_add_u32 v6, 0xfffe7d00, v6
  v_add_u32 v3, 0xfffe7d00, v3
  v_add_u32 v1, 0xc180, v1
  ds_read_b128 v[176:179], v6
  ds_read_b64_tr_b16 v[16:17], v3 offset:0
  ds_read_b64_tr_b16 v[18:19], v3 offset:1024
  ds_read_b64_tr_b16 v[20:21], v3 offset:256
  ds_read_b64_tr_b16 v[22:23], v3 offset:1280
  v_mfma_f32_32x32x16_bf16 v[64:79], v[24:27], v[108:111], v[64:79]
  v_mfma_f32_32x32x16_bf16 v[80:95], v[28:31], v[108:111], v[80:95]
  s_add_u32 s66, s75, 7
  s_cmp_ge_u32 s66, 10
  s_cselect_b32 s67, 10, 0
  s_sub_u32 s66, s66, s67
  s_add_u32 m0, s71, 117376
  s_lshl_b32 s64, s66, 7
  buffer_load_dwordx4 v4, s[24:27], s64 offen lds
  s_add_u32 s66, s75, 7
  s_cmp_ge_u32 s66, 10
  s_cselect_b32 s67, 10, 0
  s_sub_u32 s66, s66, s67
  s_add_u32 m0, s71, 117376
  s_lshl_b32 s64, s66, 7
  v_xor_b32 v11, 64, v4
  v_add_u32 v11, 9216, v11
  buffer_load_dwordx4 v11, s[24:27], s64 offen offset:1024 lds
  ds_read_b64_tr_b16 v[24:25], v1 offset:0
  ds_read_b64_tr_b16 v[26:27], v1 offset:512
  ds_read_b64_tr_b16 v[28:29], v1 offset:32
  ds_read_b64_tr_b16 v[30:31], v1 offset:544
  s_waitcnt lgkmcnt(4)
  v_mfma_f32_32x32x16_bf16 v[32:47], v[16:19], v[176:179], v[32:47]
  v_mfma_f32_32x32x16_bf16 v[48:63], v[20:23], v[176:179], v[48:63]
  s_add_u32 s66, s75, 7
  s_cmp_ge_u32 s66, 10
  s_cselect_b32 s67, 10, 0
  s_sub_u32 s66, s66, s67
  s_add_u32 m0, s71, 133888
  s_mul_i32 s64, s66, 245760
  buffer_load_dwordx4 v5, s[28:31], s64 offen lds
  s_add_u32 s66, s75, 7
  s_cmp_ge_u32 s66, 10
  s_cselect_b32 s67, 10, 0
  s_sub_u32 s66, s66, s67
  s_add_u32 m0, s71, 133888
  s_mul_i32 s64, s66, 245760
  s_add_u32 s64, s64, 14336
  buffer_load_dwordx4 v5, s[28:31], s64 offen offset:1024 lds
  v_xor_b32 v11, 32, v6
  ds_read_b128 v[180:183], v11
  ds_read_b64_tr_b16 v[16:17], v3 offset:4096
  ds_read_b64_tr_b16 v[18:19], v3 offset:5120
  ds_read_b64_tr_b16 v[20:21], v3 offset:4352
  ds_read_b64_tr_b16 v[22:23], v3 offset:5376
  s_waitcnt lgkmcnt(5)
  v_mfma_f32_32x32x16_bf16 v[64:79], v[24:27], v[112:115], v[64:79]
  v_mfma_f32_32x32x16_bf16 v[80:95], v[28:31], v[112:115], v[80:95]
  s_add_u32 s66, s75, 3
  s_cmp_ge_u32 s66, 10
  s_cselect_b32 s67, 10, 0
  s_sub_u32 s66, s66, s67
  s_mul_i32 s66, s66, 221184
  s_lshl_b32 s64, s58, 7
  s_add_u32 s64, s64, s66
  s_add_u32 m0, s70, 1792
  s_nop 0
  buffer_load_dwordx4 v2, s[32:35], s64 offen lds
  s_add_u32 s66, s75, 3
  s_cmp_ge_u32 s66, 10
  s_cselect_b32 s67, 10, 0
  s_sub_u32 s66, s66, s67
  s_mul_i32 s66, s66, 221184
  s_lshl_b32 s64, s58, 7
  s_add_u32 s64, s64, s66
  s_add_u32 m0, s70, 10016
  s_nop 0
  buffer_load_dwordx4 v2, s[36:39], s64 offen lds
  ds_read_b64_tr_b16 v[24:25], v1 offset:2048
  ds_read_b64_tr_b16 v[26:27], v1 offset:2560
  ds_read_b64_tr_b16 v[28:29], v1 offset:2080
  ds_read_b64_tr_b16 v[30:31], v1 offset:2592
  s_waitcnt lgkmcnt(4)
  v_mfma_f32_32x32x16_bf16 v[32:47], v[16:19], v[180:183], v[32:47]
  v_mfma_f32_32x32x16_bf16 v[48:63], v[20:23], v[180:183], v[48:63]
  v_xor_b32 v11, 64, v6
  ds_read_b128 v[184:187], v11
  ds_read_b64_tr_b16 v[16:17], v3 offset:8192
  ds_read_b64_tr_b16 v[18:19], v3 offset:9216
  ds_read_b64_tr_b16 v[20:21], v3 offset:8448
  ds_read_b64_tr_b16 v[22:23], v3 offset:9472
  s_waitcnt lgkmcnt(5)
  v_mfma_f32_32x32x16_bf16 v[64:79], v[24:27], v[116:119], v[64:79]
  v_mfma_f32_32x32x16_bf16 v[80:95], v[28:31], v[116:119], v[80:95]
  ds_read_b64_tr_b16 v[24:25], v1 offset:4096
  ds_read_b64_tr_b16 v[26:27], v1 offset:4608
  ds_read_b64_tr_b16 v[28:29], v1 offset:4128
  ds_read_b64_tr_b16 v[30:31], v1 offset:4640
  s_waitcnt lgkmcnt(4)
  v_mfma_f32_32x32x16_bf16 v[32:47], v[16:19], v[184:187], v[32:47]
  v_mfma_f32_32x32x16_bf16 v[48:63], v[20:23], v[184:187], v[48:63]
  v_xor_b32 v11, 96, v6
  ds_read_b128 v[188:191], v11
  ds_read_b64_tr_b16 v[16:17], v3 offset:12288
  ds_read_b64_tr_b16 v[18:19], v3 offset:13312
  ds_read_b64_tr_b16 v[20:21], v3 offset:12544
  ds_read_b64_tr_b16 v[22:23], v3 offset:13568
  s_waitcnt lgkmcnt(5)
  v_mfma_f32_32x32x16_bf16 v[64:79], v[24:27], v[120:123], v[64:79]
  v_mfma_f32_32x32x16_bf16 v[80:95], v[28:31], v[120:123], v[80:95]
  ds_read_b64_tr_b16 v[24:25], v1 offset:6144
  ds_read_b64_tr_b16 v[26:27], v1 offset:6656
  ds_read_b64_tr_b16 v[28:29], v1 offset:6176
  ds_read_b64_tr_b16 v[30:31], v1 offset:6688
  s_waitcnt lgkmcnt(4)
  v_mfma_f32_32x32x16_bf16 v[32:47], v[16:19], v[188:191], v[32:47]
  v_mfma_f32_32x32x16_bf16 v[48:63], v[20:23], v[188:191], v[48:63]
  s_waitcnt vmcnt(6)
  s_waitcnt lgkmcnt(0)
  s_barrier
  v_add_u32 v6, 0xc180, v6
  v_add_u32 v3, 0xc180, v3
  v_add_u32 v1, 0xc180, v1
  ds_read_b128 v[192:195], v6
  ds_read_b64_tr_b16 v[16:17], v3 offset:0
  ds_read_b64_tr_b16 v[18:19], v3 offset:1024
  ds_read_b64_tr_b16 v[20:21], v3 offset:256
  ds_read_b64_tr_b16 v[22:23], v3 offset:1280
  v_and_b32 v12, 3, v0
  v_lshlrev_b32 v12, 6, v12
  buffer_load_dword v9, v12, s[44:47], 0 offen sc1
  v_lshlrev_b32 v8, 2, v0
  v_mfma_f32_32x32x16_bf16 v[64:79], v[24:27], v[124:127], v[64:79]
  v_mfma_f32_32x32x16_bf16 v[80:95], v[28:31], v[124:127], v[80:95]
  s_add_u32 s66, s75, 8
  s_cmp_ge_u32 s66, 10
  s_cselect_b32 s67, 10, 0
  s_sub_u32 s66, s66, s67
  s_add_u32 m0, s71, 18304
  s_lshl_b32 s64, s66, 7
  buffer_load_dwordx4 v4, s[24:27], s64 offen lds
  s_add_u32 s66, s75, 8
  s_cmp_ge_u32 s66, 10
  s_cselect_b32 s67, 10, 0
  s_sub_u32 s66, s66, s67
  s_add_u32 m0, s71, 18304
  s_lshl_b32 s64, s66, 7
  v_xor_b32 v11, 64, v4
  v_add_u32 v11, 9216, v11
  buffer_load_dwordx4 v11, s[24:27], s64 offen offset:1024 lds
  ds_read_b64_tr_b16 v[24:25], v1 offset:0
  ds_read_b64_tr_b16 v[26:27], v1 offset:512
  ds_read_b64_tr_b16 v[28:29], v1 offset:32
  ds_read_b64_tr_b16 v[30:31], v1 offset:544
  s_waitcnt lgkmcnt(4)
  v_mfma_f32_32x32x16_bf16 v[32:47], v[16:19], v[192:195], v[32:47]
  v_mfma_f32_32x32x16_bf16 v[48:63], v[20:23], v[192:195], v[48:63]
  s_add_u32 s66, s75, 8
  s_cmp_ge_u32 s66, 10
  s_cselect_b32 s67, 10, 0
  s_sub_u32 s66, s66, s67
  s_add_u32 m0, s71, 34816
  s_mul_i32 s64, s66, 245760
  buffer_load_dwordx4 v5, s[28:31], s64 offen lds
  s_add_u32 s66, s75, 8
  s_cmp_ge_u32 s66, 10
  s_cselect_b32 s67, 10, 0
  s_sub_u32 s66, s66, s67
  s_add_u32 m0, s71, 34816
  s_mul_i32 s64, s66, 245760
  s_add_u32 s64, s64, 14336
  buffer_load_dwordx4 v5, s[28:31], s64 offen offset:1024 lds
  v_xor_b32 v11, 32, v6
  ds_read_b128 v[196:199], v11
  ds_read_b64_tr_b16 v[16:17], v3 offset:4096
  ds_read_b64_tr_b16 v[18:19], v3 offset:5120
  ds_read_b64_tr_b16 v[20:21], v3 offset:4352
  ds_read_b64_tr_b16 v[22:23], v3 offset:5376
  s_waitcnt lgkmcnt(5)
  v_mfma_f32_32x32x16_bf16 v[64:79], v[24:27], v[128:131], v[64:79]
  v_mfma_f32_32x32x16_bf16 v[80:95], v[28:31], v[128:131], v[80:95]
  s_add_u32 s66, s75, 4
  s_cmp_ge_u32 s66, 10
  s_cselect_b32 s67, 10, 0
  s_sub_u32 s66, s66, s67
  s_mul_i32 s66, s66, 221184
  s_lshl_b32 s64, s58, 7
  s_add_u32 s64, s64, s66
  s_add_u32 m0, s70, 51328
  s_nop 0
  buffer_load_dwordx4 v2, s[32:35], s64 offen lds
  s_add_u32 s66, s75, 4
  s_cmp_ge_u32 s66, 10
  s_cselect_b32 s67, 10, 0
  s_sub_u32 s66, s66, s67
  s_mul_i32 s66, s66, 221184
  s_lshl_b32 s64, s58, 7
  s_add_u32 s64, s64, s66
  s_add_u32 m0, s70, 59552
  s_nop 0
  buffer_load_dwordx4 v2, s[36:39], s64 offen lds
  ds_read_b64_tr_b16 v[24:25], v1 offset:2048
  ds_read_b64_tr_b16 v[26:27], v1 offset:2560
  ds_read_b64_tr_b16 v[28:29], v1 offset:2080
  ds_read_b64_tr_b16 v[30:31], v1 offset:2592
  s_waitcnt lgkmcnt(4)
  v_mfma_f32_32x32x16_bf16 v[32:47], v[16:19], v[196:199], v[32:47]
  v_mfma_f32_32x32x16_bf16 v[48:63], v[20:23], v[196:199], v[48:63]
  v_xor_b32 v11, 64, v6
  ds_read_b128 v[200:203], v11
  ds_read_b64_tr_b16 v[16:17], v3 offset:8192
  ds_read_b64_tr_b16 v[18:19], v3 offset:9216
  ds_read_b64_tr_b16 v[20:21], v3 offset:8448
  ds_read_b64_tr_b16 v[22:23], v3 offset:9472
  s_waitcnt lgkmcnt(5)
  v_mfma_f32_32x32x16_bf16 v[64:79], v[24:27], v[132:135], v[64:79]
  v_mfma_f32_32x32x16_bf16 v[80:95], v[28:31], v[132:135], v[80:95]
  ds_read_b64_tr_b16 v[24:25], v1 offset:4096
  ds_read_b64_tr_b16 v[26:27], v1 offset:4608
  ds_read_b64_tr_b16 v[28:29], v1 offset:4128
  ds_read_b64_tr_b16 v[30:31], v1 offset:4640
  s_waitcnt lgkmcnt(4)
  v_mfma_f32_32x32x16_bf16 v[32:47], v[16:19], v[200:203], v[32:47]
  v_mfma_f32_32x32x16_bf16 v[48:63], v[20:23], v[200:203], v[48:63]
  v_xor_b32 v11, 96, v6
  ds_read_b128 v[204:207], v11
  ds_read_b64_tr_b16 v[16:17], v3 offset:12288
  ds_read_b64_tr_b16 v[18:19], v3 offset:13312
  ds_read_b64_tr_b16 v[20:21], v3 offset:12544
  ds_read_b64_tr_b16 v[22:23], v3 offset:13568
  s_waitcnt lgkmcnt(5)
  v_mfma_f32_32x32x16_bf16 v[64:79], v[24:27], v[136:139], v[64:79]
  v_mfma_f32_32x32x16_bf16 v[80:95], v[28:31], v[136:139], v[80:95]
  ds_read_b64_tr_b16 v[24:25], v1 offset:6144
  ds_read_b64_tr_b16 v[26:27], v1 offset:6656
  ds_read_b64_tr_b16 v[28:29], v1 offset:6176
  ds_read_b64_tr_b16 v[30:31], v1 offset:6688
  s_waitcnt lgkmcnt(4)
  v_mfma_f32_32x32x16_bf16 v[32:47], v[16:19], v[204:207], v[32:47]
  v_mfma_f32_32x32x16_bf16 v[48:63], v[20:23], v[204:207], v[48:63]
  s_waitcnt vmcnt(7)
  s_waitcnt lgkmcnt(0)
  s_barrier
  v_add_u32 v6, 0xc180, v6
  v_add_u32 v3, 0xc180, v3
  v_add_u32 v1, 0xfffe7d00, v1
  ds_read_b128 v[208:211], v6
  ds_read_b64_tr_b16 v[16:17], v3 offset:0
  ds_read_b64_tr_b16 v[18:19], v3 offset:1024
  ds_read_b64_tr_b16 v[20:21], v3 offset:256
  ds_read_b64_tr_b16 v[22:23], v3 offset:1280
  v_mfma_f32_32x32x16_bf16 v[64:79], v[24:27], v[140:143], v[64:79]
  v_mfma_f32_32x32x16_bf16 v[80:95], v[28:31], v[140:143], v[80:95]
  s_add_u32 s66, s75, 9
  s_cmp_ge_u32 s66, 10
  s_cselect_b32 s67, 10, 0
  s_sub_u32 s66, s66, s67
  s_add_u32 m0, s71, 67840
  s_lshl_b32 s64, s66, 7
  buffer_load_dwordx4 v4, s[24:27], s64 offen lds
  s_add_u32 s66, s75, 9
  s_cmp_ge_u32 s66, 10
  s_cselect_b32 s67, 10, 0
  s_sub_u32 s66, s66, s67
  s_add_u32 m0, s71, 67840
  s_lshl_b32 s64, s66, 7
  v_xor_b32 v11, 64, v4
  v_add_u32 v11, 9216, v11
  buffer_load_dwordx4 v11, s[24:27], s64 offen offset:1024 lds
  ds_read_b64_tr_b16 v[24:25], v1 offset:0
  ds_read_b64_tr_b16 v[26:27], v1 offset:512
  ds_read_b64_tr_b16 v[28:29], v1 offset:32
  ds_read_b64_tr_b16 v[30:31], v1 offset:544
  s_waitcnt lgkmcnt(4)
  v_mfma_f32_32x32x16_bf16 v[32:47], v[16:19], v[208:211], v[32:47]
  v_mfma_f32_32x32x16_bf16 v[48:63], v[20:23], v[208:211], v[48:63]
  s_add_u32 s66, s75, 9
  s_cmp_ge_u32 s66, 10
  s_cselect_b32 s67, 10, 0
  s_sub_u32 s66, s66, s67
  s_add_u32 m0, s71, 84352
  s_mul_i32 s64, s66, 245760
  buffer_load_dwordx4 v5, s[28:31], s64 offen lds
  s_add_u32 s66, s75, 9
  s_cmp_ge_u32 s66, 10
  s_cselect_b32 s67, 10, 0
  s_sub_u32 s66, s66, s67
  s_add_u32 m0, s71, 84352
  s_mul_i32 s64, s66, 245760
  s_add_u32 s64, s64, 14336
  buffer_load_dwordx4 v5, s[28:31], s64 offen offset:1024 lds
  v_xor_b32 v11, 32, v6
  ds_read_b128 v[212:215], v11
  ds_read_b64_tr_b16 v[16:17], v3 offset:4096
  ds_read_b64_tr_b16 v[18:19], v3 offset:5120
  ds_read_b64_tr_b16 v[20:21], v3 offset:4352
  ds_read_b64_tr_b16 v[22:23], v3 offset:5376
  s_waitcnt lgkmcnt(5)
  v_mfma_f32_32x32x16_bf16 v[64:79], v[24:27], v[144:147], v[64:79]
  v_mfma_f32_32x32x16_bf16 v[80:95], v[28:31], v[144:147], v[80:95]
  s_add_u32 s66, s75, 5
  s_cmp_ge_u32 s66, 10
  s_cselect_b32 s67, 10, 0
  s_sub_u32 s66, s66, s67
  s_mul_i32 s66, s66, 221184
  s_lshl_b32 s64, s58, 7
  s_add_u32 s64, s64, s66
  s_add_u32 m0, s70, 100864
  s_nop 0
  buffer_load_dwordx4 v2, s[32:35], s64 offen lds
  s_add_u32 s66, s75, 5
  s_cmp_ge_u32 s66, 10
  s_cselect_b32 s67, 10, 0
  s_sub_u32 s66, s66, s67
  s_mul_i32 s66, s66, 221184
  s_lshl_b32 s64, s58, 7
  s_add_u32 s64, s64, s66
  s_add_u32 m0, s70, 109088
  s_nop 0
  buffer_load_dwordx4 v2, s[36:39], s64 offen lds
  ds_read_b64_tr_b16 v[24:25], v1 offset:2048
  ds_read_b64_tr_b16 v[26:27], v1 offset:2560
  ds_read_b64_tr_b16 v[28:29], v1 offset:2080
  ds_read_b64_tr_b16 v[30:31], v1 offset:2592
  s_waitcnt lgkmcnt(4)
  v_mfma_f32_32x32x16_bf16 v[32:47], v[16:19], v[212:215], v[32:47]
  v_mfma_f32_32x32x16_bf16 v[48:63], v[20:23], v[212:215], v[48:63]
  v_xor_b32 v11, 64, v6
  ds_read_b128 v[216:219], v11
  ds_read_b64_tr_b16 v[16:17], v3 offset:8192
  ds_read_b64_tr_b16 v[18:19], v3 offset:9216
  ds_read_b64_tr_b16 v[20:21], v3 offset:8448
  ds_read_b64_tr_b16 v[22:23], v3 offset:9472
  s_waitcnt lgkmcnt(5)
  v_mfma_f32_32x32x16_bf16 v[64:79], v[24:27], v[148:151], v[64:79]
  v_mfma_f32_32x32x16_bf16 v[80:95], v[28:31], v[148:151], v[80:95]
  ds_read_b64_tr_b16 v[24:25], v1 offset:4096
  ds_read_b64_tr_b16 v[26:27], v1 offset:4608
  ds_read_b64_tr_b16 v[28:29], v1 offset:4128
  ds_read_b64_tr_b16 v[30:31], v1 offset:4640
  s_waitcnt lgkmcnt(4)
  v_mfma_f32_32x32x16_bf16 v[32:47], v[16:19], v[216:219], v[32:47]
  v_mfma_f32_32x32x16_bf16 v[48:63], v[20:23], v[216:219], v[48:63]
  v_xor_b32 v11, 96, v6
  ds_read_b128 v[220:223], v11
  ds_read_b64_tr_b16 v[16:17], v3 offset:12288
  ds_read_b64_tr_b16 v[18:19], v3 offset:13312
  ds_read_b64_tr_b16 v[20:21], v3 offset:12544
  ds_read_b64_tr_b16 v[22:23], v3 offset:13568
  s_waitcnt lgkmcnt(5)
  v_mfma_f32_32x32x16_bf16 v[64:79], v[24:27], v[152:155], v[64:79]
  v_mfma_f32_32x32x16_bf16 v[80:95], v[28:31], v[152:155], v[80:95]
  ds_read_b64_tr_b16 v[24:25], v1 offset:6144
  ds_read_b64_tr_b16 v[26:27], v1 offset:6656
  ds_read_b64_tr_b16 v[28:29], v1 offset:6176
  ds_read_b64_tr_b16 v[30:31], v1 offset:6688
  s_waitcnt lgkmcnt(4)
  v_mfma_f32_32x32x16_bf16 v[32:47], v[16:19], v[220:223], v[32:47]
  v_mfma_f32_32x32x16_bf16 v[48:63], v[20:23], v[220:223], v[48:63]
  s_waitcnt vmcnt(6)
  s_waitcnt lgkmcnt(0)
  s_barrier
  v_add_u32 v6, 0xfffe7d00, v6
  v_add_u32 v3, 0xfffe7d00, v3
  v_add_u32 v1, 0xc180, v1
  ds_read_b128 v[224:227], v6
  ds_read_b64_tr_b16 v[16:17], v3 offset:0
  ds_read_b64_tr_b16 v[18:19], v3 offset:1024
  ds_read_b64_tr_b16 v[20:21], v3 offset:256
  ds_read_b64_tr_b16 v[22:23], v3 offset:1280
  s_cmp_eq_u32 s52, 0
  s_cbranch_scc0 L_ppok
  v_cmp_gt_u32 vcc, 64, v9
  s_nop 0
  s_cbranch_vccz L_ppok
  s_mov_b32 s79, 0
L_pppoll:
  s_sleep 8
  buffer_load_dword v9, v12, s[44:47], 0 offen sc1
  s_waitcnt vmcnt(0)
  v_cmp_gt_u32 vcc, 64, v9
  s_nop 0
  s_cbranch_vccz L_ppok
  s_add_u32 s79, s79, 1
  s_cmp_lt_u32 s79, 0x40000
  s_cbranch_scc1 L_pppoll
L_ppok:
  v_mfma_f32_32x32x16_bf16 v[64:79], v[24:27], v[156:159], v[64:79]
  v_mfma_f32_32x32x16_bf16 v[80:95], v[28:31], v[156:159], v[80:95]
  s_add_u32 s66, s75, 6
  s_cmp_ge_u32 s66, 10
  s_cselect_b32 s67, 10, 0
  s_sub_u32 s66, s66, s67
  s_mul_i32 s66, s66, 221184
  s_lshl_b32 s64, s58, 7
  s_add_u32 s64, s64, s66
  s_add_u32 m0, s70, 117376
  s_nop 0
  buffer_load_dwordx4 v2, s[32:35], s64 offen lds
  s_add_u32 s66, s75, 6
  s_cmp_ge_u32 s66, 10
  s_cselect_b32 s67, 10, 0
  s_sub_u32 s66, s66, s67
  s_mul_i32 s66, s66, 221184
  s_lshl_b32 s64, s58, 7
  s_add_u32 s64, s64, s66
  s_add_u32 m0, s70, 125600
  s_nop 0
  buffer_load_dwordx4 v2, s[36:39], s64 offen lds
  ds_read_b64_tr_b16 v[24:25], v1 offset:0
  ds_read_b64_tr_b16 v[26:27], v1 offset:512
  ds_read_b64_tr_b16 v[28:29], v1 offset:32
  ds_read_b64_tr_b16 v[30:31], v1 offset:544
  s_waitcnt lgkmcnt(4)
  v_mfma_f32_32x32x16_bf16 v[32:47], v[16:19], v[224:227], v[32:47]
  v_mfma_f32_32x32x16_bf16 v[48:63], v[20:23], v[224:227], v[48:63]
  s_add_u32 s66, s75, 7
  s_cmp_ge_u32 s66, 10
  s_cselect_b32 s67, 10, 0
  s_sub_u32 s66, s66, s67
  s_mul_i32 s66, s66, 221184
  s_lshl_b32 s64, s58, 7
  s_add_u32 s64, s64, s66
  s_add_u32 m0, s70, 133888
  s_nop 0
  buffer_load_dwordx4 v2, s[32:35], s64 offen lds
  s_add_u32 s66, s75, 7
  s_cmp_ge_u32 s66, 10
  s_cselect_b32 s67, 10, 0
  s_sub_u32 s66, s66, s67
  s_mul_i32 s66, s66, 221184
  s_lshl_b32 s64, s58, 7
  s_add_u32 s64, s64, s66
  s_add_u32 m0, s70, 142112
  s_nop 0
  buffer_load_dwordx4 v2, s[36:39], s64 offen lds
  v_xor_b32 v11, 32, v6
  ds_read_b128 v[228:231], v11
  ds_read_b64_tr_b16 v[16:17], v3 offset:4096
  ds_read_b64_tr_b16 v[18:19], v3 offset:5120
  ds_read_b64_tr_b16 v[20:21], v3 offset:4352
  ds_read_b64_tr_b16 v[22:23], v3 offset:5376
  s_waitcnt lgkmcnt(5)
  v_mfma_f32_32x32x16_bf16 v[64:79], v[24:27], v[160:163], v[64:79]
  v_mfma_f32_32x32x16_bf16 v[80:95], v[28:31], v[160:163], v[80:95]
  s_add_u32 s66, s75, 8
  s_cmp_ge_u32 s66, 10
  s_cselect_b32 s67, 10, 0
  s_sub_u32 s66, s66, s67
  s_mul_i32 s66, s66, 221184
  s_lshl_b32 s64, s58, 7
  s_add_u32 s64, s64, s66
  s_add_u32 m0, s70, 1792
  s_nop 0
  buffer_load_dwordx4 v2, s[32:35], s64 offen lds
  s_add_u32 s66, s75, 8
  s_cmp_ge_u32 s66, 10
  s_cselect_b32 s67, 10, 0
  s_sub_u32 s66, s66, s67
  s_mul_i32 s66, s66, 221184
  s_lshl_b32 s64, s58, 7
  s_add_u32 s64, s64, s66
  s_add_u32 m0, s70, 10016
  s_nop 0
  buffer_load_dwordx4 v2, s[36:39], s64 offen lds
  ds_read_b64_tr_b16 v[24:25], v1 offset:2048
  ds_read_b64_tr_b16 v[26:27], v1 offset:2560
  ds_read_b64_tr_b16 v[28:29], v1 offset:2080
  ds_read_b64_tr_b16 v[30:31], v1 offset:2592
  s_waitcnt lgkmcnt(4)
  v_mfma_f32_32x32x16_bf16 v[32:47], v[16:19], v[228:231], v[32:47]
  v_mfma_f32_32x32x16_bf16 v[48:63], v[20:23], v[228:231], v[48:63]
  v_xor_b32 v11, 64, v6
  ds_read_b128 v[232:235], v11
  ds_read_b64_tr_b16 v[16:17], v3 offset:8192
  ds_read_b64_tr_b16 v[18:19], v3 offset:9216
  ds_read_b64_tr_b16 v[20:21], v3 offset:8448
  ds_read_b64_tr_b16 v[22:23], v3 offset:9472
  s_waitcnt lgkmcnt(5)
  v_mfma_f32_32x32x16_bf16 v[64:79], v[24:27], v[164:167], v[64:79]
  v_mfma_f32_32x32x16_bf16 v[80:95], v[28:31], v[164:167], v[80:95]
  ds_read_b64_tr_b16 v[24:25], v1 offset:4096
  ds_read_b64_tr_b16 v[26:27], v1 offset:4608
  ds_read_b64_tr_b16 v[28:29], v1 offset:4128
  ds_read_b64_tr_b16 v[30:31], v1 offset:4640
  s_waitcnt lgkmcnt(4)
  v_mfma_f32_32x32x16_bf16 v[32:47], v[16:19], v[232:235], v[32:47]
  v_mfma_f32_32x32x16_bf16 v[48:63], v[20:23], v[232:235], v[48:63]
  v_xor_b32 v11, 96, v6
  ds_read_b128 v[236:239], v11
  ds_read_b64_tr_b16 v[16:17], v3 offset:12288
  ds_read_b64_tr_b16 v[18:19], v3 offset:13312
  ds_read_b64_tr_b16 v[20:21], v3 offset:12544
  ds_read_b64_tr_b16 v[22:23], v3 offset:13568
  s_waitcnt lgkmcnt(5)
  v_mfma_f32_32x32x16_bf16 v[64:79], v[24:27], v[168:171], v[64:79]
  v_mfma_f32_32x32x16_bf16 v[80:95], v[28:31], v[168:171], v[80:95]
  ds_read_b64_tr_b16 v[24:25], v1 offset:6144
  ds_read_b64_tr_b16 v[26:27], v1 offset:6656
  ds_read_b64_tr_b16 v[28:29], v1 offset:6176
  ds_read_b64_tr_b16 v[30:31], v1 offset:6688
  s_waitcnt lgkmcnt(4)
  v_mfma_f32_32x32x16_bf16 v[32:47], v[16:19], v[236:239], v[32:47]
  v_mfma_f32_32x32x16_bf16 v[48:63], v[20:23], v[236:239], v[48:63]
  s_waitcnt vmcnt(6)
  s_waitcnt lgkmcnt(0)
  s_barrier
  v_add_u32 v6, 0xc180, v6
  v_add_u32 v3, 0xc180, v3
  v_add_u32 v1, 0xc180, v1
  ds_read_b128 v[240:243], v6
  ds_read_b64_tr_b16 v[16:17], v3 offset:0
  ds_read_b64_tr_b16 v[18:19], v3 offset:1024
  ds_read_b64_tr_b16 v[20:21], v3 offset:256
  ds_read_b64_tr_b16 v[22:23], v3 offset:1280
  v_and_b32 v9, 31, v0
  v_lshlrev_b32 v9, 4, v9
  s_lshl_b32 s64, s55, 7
  s_lshl_b32 s65, s53, 5
  s_add_u32 s64, s64, s65
  s_lshl_b32 s64, s64, 4
  s_add_u32 s64, s64, 23838720
  buffer_load_dwordx2 v[4:5], v9, s[40:43], s64 offen sc1
  v_mfma_f32_32x32x16_bf16 v[64:79], v[24:27], v[172:175], v[64:79]
  s_min_u32 s65, s52, 5
  s_lshl_b32 s65, s65, 8
  s_mul_i32 s64, s56, 12288
  s_add_u32 s64, s64, 23871488
  s_add_u32 s64, s64, s65
  s_add_u32 s65, s65, 150400
  s_add_u32 m0, s65, 0
  s_add_u32 s66, s64, 0
  buffer_load_dword v8, s[40:43], s66 offen sc1 lds
  s_add_u32 m0, s65, 1536
  s_add_u32 s66, s64, 1536
  buffer_load_dword v8, s[40:43], s66 offen sc1 lds
  s_add_u32 m0, s65, 3072
  s_add_u32 s66, s64, 3072
  buffer_load_dword v8, s[40:43], s66 offen sc1 lds
  s_add_u32 m0, s65, 4608
  s_add_u32 s66, s64, 4608
  buffer_load_dword v8, s[40:43], s66 offen sc1 lds
  s_add_u32 m0, s65, 6144
  s_add_u32 s66, s64, 6144
  buffer_load_dword v8, s[40:43], s66 offen sc1 lds
  s_add_u32 m0, s65, 7680
  s_add_u32 s66, s64, 7680
  buffer_load_dword v8, s[40:43], s66 offen sc1 lds
  s_add_u32 m0, s65, 9216
  s_add_u32 s66, s64, 9216
  buffer_load_dword v8, s[40:43], s66 offen sc1 lds
  s_add_u32 m0, s65, 10752
  s_add_u32 s66, s64, 10752
  buffer_load_dword v8, s[40:43], s66 offen sc1 lds
  v_mfma_f32_32x32x16_bf16 v[80:95], v[28:31], v[172:175], v[80:95]
  s_add_u32 s66, s75, 9
  s_cmp_ge_u32 s66, 10
  s_cselect_b32 s67, 10, 0
  s_sub_u32 s66, s66, s67
  s_mul_i32 s66, s66, 221184
  s_lshl_b32 s64, s58, 7
  s_add_u32 s64, s64, s66
  s_add_u32 m0, s70, 18304
  s_nop 0
  buffer_load_dwordx4 v2, s[32:35], s64 offen lds
  s_add_u32 s66, s75, 9
  s_cmp_ge_u32 s66, 10
  s_cselect_b32 s67, 10, 0
  s_sub_u32 s66, s66, s67
  s_mul_i32 s66, s66, 221184
  s_lshl_b32 s64, s58, 7
  s_add_u32 s64, s64, s66
  s_add_u32 m0, s70, 26528
  s_nop 0
  buffer_load_dwordx4 v2, s[36:39], s64 offen lds
  ds_read_b64_tr_b16 v[24:25], v1 offset:0
  ds_read_b64_tr_b16 v[26:27], v1 offset:512
  ds_read_b64_tr_b16 v[28:29], v1 offset:32
  ds_read_b64_tr_b16 v[30:31], v1 offset:544
  s_waitcnt lgkmcnt(4)
  v_mfma_f32_32x32x16_bf16 v[32:47], v[16:19], v[240:243], v[32:47]
  v_mfma_f32_32x32x16_bf16 v[48:63], v[20:23], v[240:243], v[48:63]
  s_add_u32 s66, s75, 0
  s_cmp_ge_u32 s66, 10
  s_cselect_b32 s67, 10, 0
  s_sub_u32 s66, s66, s67
  s_mul_i32 s66, s66, 221184
  s_lshl_b32 s64, s58, 7
  s_add_u32 s64, s64, s66
  s_add_u32 s64, s64, 128
  s_add_u32 m0, s70, 34816
  s_nop 0
  buffer_load_dwordx4 v2, s[32:35], s64 offen lds
  s_add_u32 s66, s75, 0
  s_cmp_ge_u32 s66, 10
  s_cselect_b32 s67, 10, 0
  s_sub_u32 s66, s66, s67
  s_mul_i32 s66, s66, 221184
  s_lshl_b32 s64, s58, 7
  s_add_u32 s64, s64, s66
  s_add_u32 s64, s64, 128
  s_add_u32 m0, s70, 43040
  s_nop 0
  buffer_load_dwordx4 v2, s[36:39], s64 offen lds
  v_xor_b32 v11, 32, v6
  ds_read_b128 v[244:247], v11
  ds_read_b64_tr_b16 v[16:17], v3 offset:4096
  ds_read_b64_tr_b16 v[18:19], v3 offset:5120
  ds_read_b64_tr_b16 v[20:21], v3 offset:4352
  ds_read_b64_tr_b16 v[22:23], v3 offset:5376
  s_waitcnt lgkmcnt(5)
  v_mfma_f32_32x32x16_bf16 v[64:79], v[24:27], v[176:179], v[64:79]
  v_mfma_f32_32x32x16_bf16 v[80:95], v[28:31], v[176:179], v[80:95]
  s_add_u32 s66, s75, 1
  s_cmp_ge_u32 s66, 10
  s_cselect_b32 s67, 10, 0
  s_sub_u32 s66, s66, s67
  s_mul_i32 s66, s66, 221184
  s_lshl_b32 s64, s58, 7
  s_add_u32 s64, s64, s66
  s_add_u32 s64, s64, 128
  s_add_u32 m0, s70, 51328
  s_nop 0
  buffer_load_dwordx4 v2, s[32:35], s64 offen lds
  s_add_u32 s66, s75, 1
  s_cmp_ge_u32 s66, 10
  s_cselect_b32 s67, 10, 0
  s_sub_u32 s66, s66, s67
  s_mul_i32 s66, s66, 221184
  s_lshl_b32 s64, s58, 7
  s_add_u32 s64, s64, s66
  s_add_u32 s64, s64, 128
  s_add_u32 m0, s70, 59552
  s_nop 0
  buffer_load_dwordx4 v2, s[36:39], s64 offen lds
  ds_read_b64_tr_b16 v[24:25], v1 offset:2048
  ds_read_b64_tr_b16 v[26:27], v1 offset:2560
  ds_read_b64_tr_b16 v[28:29], v1 offset:2080
  ds_read_b64_tr_b16 v[30:31], v1 offset:2592
  s_waitcnt lgkmcnt(4)
  v_mfma_f32_32x32x16_bf16 v[32:47], v[16:19], v[244:247], v[32:47]
  v_mfma_f32_32x32x16_bf16 v[48:63], v[20:23], v[244:247], v[48:63]
  v_xor_b32 v11, 64, v6
  ds_read_b128 v[248:251], v11
  ds_read_b64_tr_b16 v[16:17], v3 offset:8192
  ds_read_b64_tr_b16 v[18:19], v3 offset:9216
  ds_read_b64_tr_b16 v[20:21], v3 offset:8448
  ds_read_b64_tr_b16 v[22:23], v3 offset:9472
  s_waitcnt lgkmcnt(5)
  v_mfma_f32_32x32x16_bf16 v[64:79], v[24:27], v[180:183], v[64:79]
  v_mfma_f32_32x32x16_bf16 v[80:95], v[28:31], v[180:183], v[80:95]
  ds_read_b64_tr_b16 v[24:25], v1 offset:4096
  ds_read_b64_tr_b16 v[26:27], v1 offset:4608
  ds_read_b64_tr_b16 v[28:29], v1 offset:4128
  ds_read_b64_tr_b16 v[30:31], v1 offset:4640
  s_waitcnt lgkmcnt(4)
  v_mfma_f32_32x32x16_bf16 v[32:47], v[16:19], v[248:251], v[32:47]
  v_mfma_f32_32x32x16_bf16 v[48:63], v[20:23], v[248:251], v[48:63]
  v_xor_b32 v11, 96, v6
  ds_read_b128 v[252:255], v11
  ds_read_b64_tr_b16 v[16:17], v3 offset:12288
  ds_read_b64_tr_b16 v[18:19], v3 offset:13312
  ds_read_b64_tr_b16 v[20:21], v3 offset:12544
  ds_read_b64_tr_b16 v[22:23], v3 offset:13568
  s_waitcnt lgkmcnt(5)
  v_mfma_f32_32x32x16_bf16 v[64:79], v[24:27], v[184:187], v[64:79]
  v_mfma_f32_32x32x16_bf16 v[80:95], v[28:31], v[184:187], v[80:95]
  ds_read_b64_tr_b16 v[24:25], v1 offset:6144
  ds_read_b64_tr_b16 v[26:27], v1 offset:6656
  ds_read_b64_tr_b16 v[28:29], v1 offset:6176
  ds_read_b64_tr_b16 v[30:31], v1 offset:6688
  s_waitcnt lgkmcnt(4)
  v_mfma_f32_32x32x16_bf16 v[32:47], v[16:19], v[252:255], v[32:47]
  v_mfma_f32_32x32x16_bf16 v[48:63], v[20:23], v[252:255], v[48:63]
  s_waitcnt vmcnt(19)
  s_waitcnt lgkmcnt(0)
  s_barrier
  v_add_u32 v1, 0x4080, v1
  ds_read_b64_tr_b16 v[16:17], v1 offset:0
  ds_read_b64_tr_b16 v[18:19], v1 offset:512
  ds_read_b64_tr_b16 v[20:21], v1 offset:32
  ds_read_b64_tr_b16 v[22:23], v1 offset:544
  s_waitcnt vmcnt(6)
  v_lshlrev_b32 v8, 2, v0
  s_min_u32 s65, s52, 5
  s_lshl_b32 s65, s65, 8
  v_add_u32 v8, s65, v8
  v_add_u32 v10, 150400, v8
  v_mov_b32 v9, 0
  v_mfma_f32_32x32x16_bf16 v[64:79], v[24:27], v[188:191], v[64:79]
  ds_read_b32 v12, v10 offset:0
  ds_read_b32 v13, v10 offset:1536
  ds_read_b32 v14, v10 offset:3072
  ds_read_b32 v15, v10 offset:4608
  v_mfma_f32_32x32x16_bf16 v[80:95], v[28:31], v[188:191], v[80:95]
  s_add_u32 s66, s75, 2
  s_cmp_ge_u32 s66, 10
  s_cselect_b32 s67, 10, 0
  s_sub_u32 s66, s66, s67
  s_mul_i32 s66, s66, 221184
  s_lshl_b32 s64, s58, 7
  s_add_u32 s64, s64, s66
  s_add_u32 s64, s64, 128
  s_add_u32 m0, s70, 67840
  s_nop 0
  buffer_load_dwordx4 v2, s[32:35], s64 offen lds
  s_add_u32 s66, s75, 2
  s_cmp_ge_u32 s66, 10
  s_cselect_b32 s67, 10, 0
  s_sub_u32 s66, s66, s67
  s_mul_i32 s66, s66, 221184
  s_lshl_b32 s64, s58, 7
  s_add_u32 s64, s64, s66
  s_add_u32 s64, s64, 128
  s_add_u32 m0, s70, 76064
  s_nop 0
  buffer_load_dwordx4 v2, s[36:39], s64 offen lds
  ds_read_b64_tr_b16 v[24:25], v1 offset:2048
  ds_read_b64_tr_b16 v[26:27], v1 offset:2560
  ds_read_b64_tr_b16 v[28:29], v1 offset:2080
  ds_read_b64_tr_b16 v[30:31], v1 offset:2592
  s_waitcnt lgkmcnt(4)
  v_add_f32 v9, v9, v12
  v_add_f32 v9, v9, v13
  v_add_f32 v9, v9, v14
  v_add_f32 v9, v9, v15
  v_mfma_f32_32x32x16_bf16 v[64:79], v[16:19], v[192:195], v[64:79]
  ds_read_b32 v12, v10 offset:6144
  ds_read_b32 v13, v10 offset:7680
  ds_read_b32 v14, v10 offset:9216
  ds_read_b32 v15, v10 offset:10752
  v_mfma_f32_32x32x16_bf16 v[80:95], v[20:23], v[192:195], v[80:95]
  s_add_u32 s66, s75, 3
  s_cmp_ge_u32 s66, 10
  s_cselect_b32 s67, 10, 0
  s_sub_u32 s66, s66, s67
  s_mul_i32 s66, s66, 221184
  s_lshl_b32 s64, s58, 7
  s_add_u32 s64, s64, s66
  s_add_u32 s64, s64, 128
  s_add_u32 m0, s70, 84352
  s_nop 0
  buffer_load_dwordx4 v2, s[32:35], s64 offen lds
  s_add_u32 s66, s75, 3
  s_cmp_ge_u32 s66, 10
  s_cselect_b32 s67, 10, 0
  s_sub_u32 s66, s66, s67
  s_mul_i32 s66, s66, 221184
  s_lshl_b32 s64, s58, 7
  s_add_u32 s64, s64, s66
  s_add_u32 s64, s64, 128
  s_add_u32 m0, s70, 92576
  s_nop 0
  buffer_load_dwordx4 v2, s[36:39], s64 offen lds
  ds_read_b64_tr_b16 v[16:17], v1 offset:4096
  ds_read_b64_tr_b16 v[18:19], v1 offset:4608
  ds_read_b64_tr_b16 v[20:21], v1 offset:4128
  ds_read_b64_tr_b16 v[22:23], v1 offset:4640
  s_waitcnt lgkmcnt(4)
  v_add_f32 v9, v9, v12
  v_add_f32 v9, v9, v13
  v_add_f32 v9, v9, v14
  v_add_f32 v9, v9, v15
  v_lshrrev_b32 v12, 5, v8
  v_lshrrev_b32 v13, 4, v12
  v_lshlrev_b32 v13, 7, v13
  v_bfe_u32 v14, v12, 1, 2
  v_lshl_add_u32 v13, v14, 5, v13
  v_and_b32 v14, 1, v12
  v_lshl_add_u32 v13, v14, 3, v13
  v_bfe_u32 v14, v12, 3, 1
  v_lshl_add_u32 v13, v14, 4, v13
  v_bfe_u32 v14, v8, 2, 3
  v_add_u32 v13, v13, v14
  v_lshlrev_b32 v13, 2, v13
  v_cmp_gt_u32 vcc, 16, v12
  s_nop 1
  v_cndmask_b32 v13, v13, v8, vcc
  ds_write_b32 v13, v9 offset:0
  v_mfma_f32_32x32x16_bf16 v[64:79], v[24:27], v[196:199], v[64:79]
  v_mfma_f32_32x32x16_bf16 v[80:95], v[28:31], v[196:199], v[80:95]
  s_add_u32 s66, s75, 4
  s_cmp_ge_u32 s66, 10
  s_cselect_b32 s67, 10, 0
  s_sub_u32 s66, s66, s67
  s_mul_i32 s66, s66, 221184
  s_lshl_b32 s64, s58, 7
  s_add_u32 s64, s64, s66
  s_add_u32 s64, s64, 128
  s_add_u32 m0, s70, 100864
  s_nop 0
  buffer_load_dwordx4 v2, s[32:35], s64 offen lds
  s_add_u32 s66, s75, 4
  s_cmp_ge_u32 s66, 10
  s_cselect_b32 s67, 10, 0
  s_sub_u32 s66, s66, s67
  s_mul_i32 s66, s66, 221184
  s_lshl_b32 s64, s58, 7
  s_add_u32 s64, s64, s66
  s_add_u32 s64, s64, 128
  s_add_u32 m0, s70, 109088
  s_nop 0
  buffer_load_dwordx4 v2, s[36:39], s64 offen lds
  ds_read_b64_tr_b16 v[24:25], v1 offset:6144
  ds_read_b64_tr_b16 v[26:27], v1 offset:6656
  ds_read_b64_tr_b16 v[28:29], v1 offset:6176
  ds_read_b64_tr_b16 v[30:31], v1 offset:6688
  s_waitcnt lgkmcnt(5)
  v_mfma_f32_32x32x16_bf16 v[64:79], v[16:19], v[200:203], v[64:79]
  v_mfma_f32_32x32x16_bf16 v[80:95], v[20:23], v[200:203], v[80:95]
  s_waitcnt lgkmcnt(4)
  s_waitcnt lgkmcnt(0)
  s_barrier
  v_add_u32 v1, 0x4080, v1
  ds_read_b64_tr_b16 v[16:17], v1 offset:0
  ds_read_b64_tr_b16 v[18:19], v1 offset:512
  ds_read_b64_tr_b16 v[20:21], v1 offset:32
  ds_read_b64_tr_b16 v[22:23], v1 offset:544
  s_cmp_lt_u32 s56, 15
  s_cselect_b32 s50, 24100864, 0
  s_lshl_b32 s66, s57, 2
  s_lshl_b32 s67, s54, 1
  s_add_u32 s66, s66, s67
  s_add_u32 s66, s66, 0
  s_cmp_lt_u32 s66, 20
  s_cselect_b32 s67, 0x3ea52b5c, 0x3f800000
  s_lshl_b32 s76, s66, 17
  v_mul_f32 v9, s67, v5
  s_lshl_b32 s67, s54, 8
  v_lshlrev_b32 v8, 4, v7
  v_add_u32 v8, s67, v8
  v_and_b32 v6, 31, v0
  s_lshl_b32 s67, s55, 7
  s_lshl_b32 s68, s53, 5
  s_add_u32 s67, s67, s68
  v_add_u32 v6, s67, v6
  v_lshlrev_b32 v6, 3, v6
  v_lshl_add_u32 v6, v7, 14, v6
  ds_read_b128 v[12:15], v8 offset:0
  s_waitcnt lgkmcnt(0)
  v_fma_f32 v32, -v4, v12, v32
  v_fma_f32 v33, -v4, v13, v33
  v_fma_f32 v34, -v4, v14, v34
  v_fma_f32 v35, -v4, v15, v35
  v_mfma_f32_32x32x16_bf16 v[64:79], v[24:27], v[204:207], v[64:79]
  v_mul_f32 v32, v9, v32
  v_mul_f32 v33, v9, v33
  v_mul_f32 v34, v9, v34
  v_mul_f32 v35, v9, v35
  v_mfma_f32_32x32x16_bf16 v[80:95], v[28:31], v[204:207], v[80:95]
  s_add_u32 s66, s75, 5
  s_cmp_ge_u32 s66, 10
  s_cselect_b32 s67, 10, 0
  s_sub_u32 s66, s66, s67
  s_mul_i32 s66, s66, 221184
  s_lshl_b32 s64, s58, 7
  s_add_u32 s64, s64, s66
  s_add_u32 s64, s64, 128
  s_add_u32 m0, s70, 117376
  s_nop 0
  buffer_load_dwordx4 v2, s[32:35], s64 offen lds
  s_add_u32 s66, s75, 5
  s_cmp_ge_u32 s66, 10
  s_cselect_b32 s67, 10, 0
  s_sub_u32 s66, s66, s67
  s_mul_i32 s66, s66, 221184
  s_lshl_b32 s64, s58, 7
  s_add_u32 s64, s64, s66
  s_add_u32 s64, s64, 128
  s_add_u32 m0, s70, 125600
  s_nop 0
  buffer_load_dwordx4 v2, s[36:39], s64 offen lds
  ds_read_b64_tr_b16 v[24:25], v1 offset:2048
  ds_read_b64_tr_b16 v[26:27], v1 offset:2560
  ds_read_b64_tr_b16 v[28:29], v1 offset:2080
  ds_read_b64_tr_b16 v[30:31], v1 offset:2592
  v_cvt_pk_bf16_f32 v32, v32, v33
  v_cvt_pk_bf16_f32 v33, v34, v35
  s_add_u32 s69, s76, 0
  buffer_store_dwordx2 v[32:33], v6, s[48:51], s69 offen sc1
  ds_read_b128 v[12:15], v8 offset:32
  s_waitcnt lgkmcnt(0)
  v_fma_f32 v36, -v4, v12, v36
  v_fma_f32 v37, -v4, v13, v37
  v_fma_f32 v38, -v4, v14, v38
  v_fma_f32 v39, -v4, v15, v39
  v_mul_f32 v36, v9, v36
  v_mul_f32 v37, v9, v37
  v_mul_f32 v38, v9, v38
  v_mul_f32 v39, v9, v39
  v_mfma_f32_32x32x16_bf16 v[64:79], v[16:19], v[208:211], v[64:79]
  v_cvt_pk_bf16_f32 v36, v36, v37
  v_cvt_pk_bf16_f32 v37, v38, v39
  s_add_u32 s69, s76, 32768
  buffer_store_dwordx2 v[36:37], v6, s[48:51], s69 offen sc1
  v_mfma_f32_32x32x16_bf16 v[80:95], v[20:23], v[208:211], v[80:95]
  ds_read_b64_tr_b16 v[16:17], v1 offset:4096
  ds_read_b64_tr_b16 v[18:19], v1 offset:4608
  ds_read_b64_tr_b16 v[20:21], v1 offset:4128
  ds_read_b64_tr_b16 v[22:23], v1 offset:4640
  ds_read_b128 v[12:15], v8 offset:64
  s_waitcnt lgkmcnt(0)
  v_fma_f32 v40, -v4, v12, v40
  v_fma_f32 v41, -v4, v13, v41
  v_fma_f32 v42, -v4, v14, v42
  v_fma_f32 v43, -v4, v15, v43
  v_mul_f32 v40, v9, v40
  v_mul_f32 v41, v9, v41
  v_mul_f32 v42, v9, v42
  v_mul_f32 v43, v9, v43
  v_cvt_pk_bf16_f32 v40, v40, v41
  v_cvt_pk_bf16_f32 v41, v42, v43
  s_add_u32 s69, s76, 65536
  buffer_store_dwordx2 v[40:41], v6, s[48:51], s69 offen sc1
  v_mfma_f32_32x32x16_bf16 v[64:79], v[24:27], v[212:215], v[64:79]
  ds_read_b128 v[12:15], v8 offset:96
  s_waitcnt lgkmcnt(0)
  v_fma_f32 v44, -v4, v12, v44
  v_fma_f32 v45, -v4, v13, v45
  v_fma_f32 v46, -v4, v14, v46
  v_fma_f32 v47, -v4, v15, v47
  v_mfma_f32_32x32x16_bf16 v[80:95], v[28:31], v[212:215], v[80:95]
  ds_read_b64_tr_b16 v[24:25], v1 offset:6144
  ds_read_b64_tr_b16 v[26:27], v1 offset:6656
  ds_read_b64_tr_b16 v[28:29], v1 offset:6176
  ds_read_b64_tr_b16 v[30:31], v1 offset:6688
  v_mul_f32 v44, v9, v44
  v_mul_f32 v45, v9, v45
  v_mul_f32 v46, v9, v46
  v_mul_f32 v47, v9, v47
  v_cvt_pk_bf16_f32 v44, v44, v45
  v_cvt_pk_bf16_f32 v45, v46, v47
  s_add_u32 s69, s76, 98304
  buffer_store_dwordx2 v[44:45], v6, s[48:51], s69 offen sc1
  s_cmp_lt_u32 s56, 15
  s_cselect_b32 s50, 24100864, 0
  s_lshl_b32 s66, s57, 2
  s_lshl_b32 s67, s54, 1
  s_add_u32 s66, s66, s67
  s_add_u32 s66, s66, 1
  s_cmp_lt_u32 s66, 20
  s_cselect_b32 s67, 0x3ea52b5c, 0x3f800000
  s_lshl_b32 s76, s66, 17
  v_mul_f32 v9, s67, v5
  s_lshl_b32 s67, s54, 8
  v_lshlrev_b32 v8, 4, v7
  v_add_u32 v8, s67, v8
  v_mfma_f32_32x32x16_bf16 v[64:79], v[16:19], v[216:219], v[64:79]
  ds_read_b128 v[12:15], v8 offset:128
  s_waitcnt lgkmcnt(0)
  v_fma_f32 v48, -v4, v12, v48
  v_fma_f32 v49, -v4, v13, v49
  v_fma_f32 v50, -v4, v14, v50
  v_fma_f32 v51, -v4, v15, v51
  v_mfma_f32_32x32x16_bf16 v[80:95], v[20:23], v[216:219], v[80:95]
  s_barrier
  v_add_u32 v1, 0xfffdfc00, v1
  ds_read_b64_tr_b16 v[16:17], v1 offset:0
  ds_read_b64_tr_b16 v[18:19], v1 offset:512
  ds_read_b64_tr_b16 v[20:21], v1 offset:32
  ds_read_b64_tr_b16 v[22:23], v1 offset:544
  v_mul_f32 v48, v9, v48
  v_mul_f32 v49, v9, v49
  v_mul_f32 v50, v9, v50
  v_mul_f32 v51, v9, v51
  v_cvt_pk_bf16_f32 v48, v48, v49
  v_cvt_pk_bf16_f32 v49, v50, v51
  s_add_u32 s69, s76, 0
  buffer_store_dwordx2 v[48:49], v6, s[48:51], s69 offen sc1
  ds_read_b128 v[12:15], v8 offset:160
  s_waitcnt lgkmcnt(0)
  v_fma_f32 v52, -v4, v12, v52
  v_fma_f32 v53, -v4, v13, v53
  v_fma_f32 v54, -v4, v14, v54
  v_fma_f32 v55, -v4, v15, v55
  v_mfma_f32_32x32x16_bf16 v[64:79], v[24:27], v[220:223], v[64:79]
  v_mul_f32 v52, v9, v52
  v_mul_f32 v53, v9, v53
  v_mul_f32 v54, v9, v54
  v_mul_f32 v55, v9, v55
  v_mfma_f32_32x32x16_bf16 v[80:95], v[28:31], v[220:223], v[80:95]
  s_add_u32 s66, s75, 6
  s_cmp_ge_u32 s66, 10
  s_cselect_b32 s67, 10, 0
  s_sub_u32 s66, s66, s67
  s_mul_i32 s66, s66, 221184
  s_lshl_b32 s64, s58, 7
  s_add_u32 s64, s64, s66
  s_add_u32 s64, s64, 128
  s_add_u32 m0, s70, 133888
  s_nop 0
  buffer_load_dwordx4 v2, s[32:35], s64 offen lds
  s_add_u32 s66, s75, 6
  s_cmp_ge_u32 s66, 10
  s_cselect_b32 s67, 10, 0
  s_sub_u32 s66, s66, s67
  s_mul_i32 s66, s66, 221184
  s_lshl_b32 s64, s58, 7
  s_add_u32 s64, s64, s66
  s_add_u32 s64, s64, 128
  s_add_u32 m0, s70, 142112
  s_nop 0
  buffer_load_dwordx4 v2, s[36:39], s64 offen lds
  ds_read_b64_tr_b16 v[24:25], v1 offset:2048
  ds_read_b64_tr_b16 v[26:27], v1 offset:2560
  ds_read_b64_tr_b16 v[28:29], v1 offset:2080
  ds_read_b64_tr_b16 v[30:31], v1 offset:2592
  v_cvt_pk_bf16_f32 v52, v52, v53
  v_cvt_pk_bf16_f32 v53, v54, v55
  s_add_u32 s69, s76, 32768
  buffer_store_dwordx2 v[52:53], v6, s[48:51], s69 offen sc1
  ds_read_b128 v[12:15], v8 offset:192
  s_waitcnt lgkmcnt(0)
  v_fma_f32 v56, -v4, v12, v56
  v_fma_f32 v57, -v4, v13, v57
  v_fma_f32 v58, -v4, v14, v58
  v_fma_f32 v59, -v4, v15, v59
  v_mul_f32 v56, v9, v56
  v_mul_f32 v57, v9, v57
  v_mul_f32 v58, v9, v58
  v_mul_f32 v59, v9, v59
  v_mfma_f32_32x32x16_bf16 v[64:79], v[16:19], v[224:227], v[64:79]
  v_cvt_pk_bf16_f32 v56, v56, v57
  v_cvt_pk_bf16_f32 v57, v58, v59
  s_add_u32 s69, s76, 65536
  buffer_store_dwordx2 v[56:57], v6, s[48:51], s69 offen sc1
  v_mfma_f32_32x32x16_bf16 v[80:95], v[20:23], v[224:227], v[80:95]
  ds_read_b64_tr_b16 v[16:17], v1 offset:4096
  ds_read_b64_tr_b16 v[18:19], v1 offset:4608
  ds_read_b64_tr_b16 v[20:21], v1 offset:4128
  ds_read_b64_tr_b16 v[22:23], v1 offset:4640
  ds_read_b128 v[12:15], v8 offset:224
  s_waitcnt lgkmcnt(0)
  v_fma_f32 v60, -v4, v12, v60
  v_fma_f32 v61, -v4, v13, v61
  v_fma_f32 v62, -v4, v14, v62
  v_fma_f32 v63, -v4, v15, v63
  v_mul_f32 v60, v9, v60
  v_mul_f32 v61, v9, v61
  v_mul_f32 v62, v9, v62
  v_mul_f32 v63, v9, v63
  v_cvt_pk_bf16_f32 v60, v60, v61
  v_cvt_pk_bf16_f32 v61, v62, v63
  s_add_u32 s69, s76, 98304
  buffer_store_dwordx2 v[60:61], v6, s[48:51], s69 offen sc1
  v_mfma_f32_32x32x16_bf16 v[64:79], v[24:27], v[228:231], v[64:79]
  v_mfma_f32_32x32x16_bf16 v[80:95], v[28:31], v[228:231], v[80:95]
  ds_read_b64_tr_b16 v[24:25], v1 offset:6144
  ds_read_b64_tr_b16 v[26:27], v1 offset:6656
  ds_read_b64_tr_b16 v[28:29], v1 offset:6176
  ds_read_b64_tr_b16 v[30:31], v1 offset:6688
  v_mfma_f32_32x32x16_bf16 v[64:79], v[16:19], v[232:235], v[64:79]
  v_mfma_f32_32x32x16_bf16 v[80:95], v[20:23], v[232:235], v[80:95]
  s_waitcnt vmcnt(22)
  s_waitcnt lgkmcnt(0)
  s_barrier
  v_add_u32 v1, 0x4080, v1
  ds_read_b64_tr_b16 v[16:17], v1 offset:0
  ds_read_b64_tr_b16 v[18:19], v1 offset:512
  ds_read_b64_tr_b16 v[20:21], v1 offset:32
  ds_read_b64_tr_b16 v[22:23], v1 offset:544
  v_mfma_f32_32x32x16_bf16 v[64:79], v[24:27], v[236:239], v[64:79]
  v_mfma_f32_32x32x16_bf16 v[80:95], v[28:31], v[236:239], v[80:95]
  s_add_u32 s66, s75, 7
  s_cmp_ge_u32 s66, 10
  s_cselect_b32 s67, 10, 0
  s_sub_u32 s66, s66, s67
  s_mul_i32 s66, s66, 221184
  s_lshl_b32 s64, s58, 7
  s_add_u32 s64, s64, s66
  s_add_u32 s64, s64, 128
  s_add_u32 m0, s70, 1792
  s_nop 0
  buffer_load_dwordx4 v2, s[32:35], s64 offen lds
  s_add_u32 s66, s75, 7
  s_cmp_ge_u32 s66, 10
  s_cselect_b32 s67, 10, 0
  s_sub_u32 s66, s66, s67
  s_mul_i32 s66, s66, 221184
  s_lshl_b32 s64, s58, 7
  s_add_u32 s64, s64, s66
  s_add_u32 s64, s64, 128
  s_add_u32 m0, s70, 10016
  s_nop 0
  buffer_load_dwordx4 v2, s[36:39], s64 offen lds
  ds_read_b64_tr_b16 v[24:25], v1 offset:2048
  ds_read_b64_tr_b16 v[26:27], v1 offset:2560
  ds_read_b64_tr_b16 v[28:29], v1 offset:2080
  ds_read_b64_tr_b16 v[30:31], v1 offset:2592
  s_waitcnt lgkmcnt(4)
  v_mfma_f32_32x32x16_bf16 v[64:79], v[16:19], v[240:243], v[64:79]
  v_mfma_f32_32x32x16_bf16 v[80:95], v[20:23], v[240:243], v[80:95]
  ds_read_b64_tr_b16 v[16:17], v1 offset:4096
  ds_read_b64_tr_b16 v[18:19], v1 offset:4608
  ds_read_b64_tr_b16 v[20:21], v1 offset:4128
  ds_read_b64_tr_b16 v[22:23], v1 offset:4640
  s_waitcnt lgkmcnt(4)
  v_mfma_f32_32x32x16_bf16 v[64:79], v[24:27], v[244:247], v[64:79]
  v_mfma_f32_32x32x16_bf16 v[80:95], v[28:31], v[244:247], v[80:95]
  ds_read_b64_tr_b16 v[24:25], v1 offset:6144
  ds_read_b64_tr_b16 v[26:27], v1 offset:6656
  ds_read_b64_tr_b16 v[28:29], v1 offset:6176
  ds_read_b64_tr_b16 v[30:31], v1 offset:6688
  s_cmp_eq_u32 s59, 0
  s_cbranch_scc1 L_nop2
  s_waitcnt lgkmcnt(4)
  v_mfma_f32_32x32x16_bf16 v[64:79], v[16:19], v[248:251], v[64:79]
  v_mfma_f32_32x32x16_bf16 v[80:95], v[20:23], v[248:251], v[80:95]
  s_waitcnt vmcnt(22)
  s_waitcnt vmcnt(2)
  s_waitcnt lgkmcnt(0)
  s_barrier
  v_add_u32 v1, 0x4080, v1
  ds_read_b64_tr_b16 v[16:17], v1 offset:0
  ds_read_b64_tr_b16 v[18:19], v1 offset:512
  ds_read_b64_tr_b16 v[20:21], v1 offset:32
  ds_read_b64_tr_b16 v[22:23], v1 offset:544
  s_cmp_eq_u32 s52, 0
  s_cbranch_scc0 L_pub1_2010
  v_mov_b32 v12, 1
  v_mov_b32 v13, 1
  v_mov_b32 v14, 1
  v_mov_b32 v15, 1
  v_mbcnt_lo_u32_b32 v10, -1, 0
  v_lshlrev_b32 v10, 4, v10
  s_lshl_b32 s64, s60, 7
  s_add_u32 s64, s64, 24068096
  s_mov_b64 s[72:73], exec
  s_mov_b64 exec, 0xff
  buffer_store_dwordx4 v[12:15], v10, s[40:43], s64 offen sc1
  s_mov_b64 exec, s[72:73]
L_pub1_2010:
  v_mfma_f32_32x32x16_bf16 v[64:79], v[24:27], v[252:255], v[64:79]
  v_mfma_f32_32x32x16_bf16 v[80:95], v[28:31], v[252:255], v[80:95]
  s_add_u32 s66, s75, 8
  s_cmp_ge_u32 s66, 10
  s_cselect_b32 s67, 10, 0
  s_sub_u32 s66, s66, s67
  s_mul_i32 s66, s66, 221184
  s_lshl_b32 s64, s58, 7
  s_add_u32 s64, s64, s66
  s_add_u32 s64, s64, 128
  s_add_u32 m0, s70, 18304
  s_nop 0
  buffer_load_dwordx4 v2, s[32:35], s64 offen lds
  s_add_u32 s66, s75, 8
  s_cmp_ge_u32 s66, 10
  s_cselect_b32 s67, 10, 0
  s_sub_u32 s66, s66, s67
  s_mul_i32 s66, s66, 221184
  s_lshl_b32 s64, s58, 7
  s_add_u32 s64, s64, s66
  s_add_u32 s64, s64, 128
  s_add_u32 m0, s70, 26528
  s_nop 0
  buffer_load_dwordx4 v2, s[36:39], s64 offen lds
  ds_read_b64_tr_b16 v[24:25], v1 offset:2048
  ds_read_b64_tr_b16 v[26:27], v1 offset:2560
  ds_read_b64_tr_b16 v[28:29], v1 offset:2080
  ds_read_b64_tr_b16 v[30:31], v1 offset:2592
  s_waitcnt lgkmcnt(4)
  v_mfma_f32_32x32x16_bf16 v[32:47], v[16:19], v[96:99], 0
  v_mfma_f32_32x32x16_bf16 v[48:63], v[20:23], v[96:99], 0
  ds_read_b64_tr_b16 v[16:17], v1 offset:4096
  ds_read_b64_tr_b16 v[18:19], v1 offset:4608
  ds_read_b64_tr_b16 v[20:21], v1 offset:4128
  ds_read_b64_tr_b16 v[22:23], v1 offset:4640
  s_waitcnt lgkmcnt(4)
  v_mfma_f32_32x32x16_bf16 v[32:47], v[24:27], v[100:103], v[32:47]
  s_mov_b32 s50, 24100864
  s_add_u32 s66, s58, 0
  s_lshl_b32 s66, s66, 2
  s_lshl_b32 s67, s54, 1
  s_add_u32 s66, s66, s67
  s_add_u32 s66, s66, 0
  s_lshr_b32 s76, s66, 2
  s_mul_i32 s76, s76, 10240
  s_and_b32 s67, s66, 3
  s_lshl_b32 s67, s67, 11
  s_add_u32 s76, s76, s67
  v_mul_f32 v9, v5, v5
  s_lshl_b32 s67, s54, 8
  v_lshlrev_b32 v8, 4, v7
  v_add_u32 v8, s67, v8
  v_and_b32 v6, 31, v0
  s_and_b32 s67, s53, 1
  s_lshl_b32 s67, s67, 5
  v_add_u32 v6, s67, v6
  v_lshlrev_b32 v6, 4, v6
  v_lshl_add_u32 v6, v7, 10, v6
  s_lshl_b32 s67, s55, 1
  s_lshr_b32 s68, s53, 1
  s_add_u32 s67, s67, s68
  s_mul_i32 s67, s67, 399360
  s_add_u32 s67, s67, 7864320
  v_add_u32 v6, s67, v6
  v_mfma_f32_32x32x16_bf16 v[48:63], v[28:31], v[100:103], v[48:63]
  ds_read_b64_tr_b16 v[24:25], v1 offset:6144
  ds_read_b64_tr_b16 v[26:27], v1 offset:6656
  ds_read_b64_tr_b16 v[28:29], v1 offset:6176
  ds_read_b64_tr_b16 v[30:31], v1 offset:6688
  ds_read_b128 v[12:15], v8 offset:512
  s_waitcnt lgkmcnt(0)
  v_fma_f32 v64, -v4, v12, v64
  v_fma_f32 v65, -v4, v13, v65
  v_fma_f32 v66, -v4, v14, v66
  v_fma_f32 v67, -v4, v15, v67
  ds_read_b128 v[12:15], v8 offset:544
  s_waitcnt lgkmcnt(0)
  v_fma_f32 v68, -v4, v12, v68
  v_fma_f32 v69, -v4, v13, v69
  v_fma_f32 v70, -v4, v14, v70
  v_fma_f32 v71, -v4, v15, v71
  ds_read_b128 v[12:15], v8 offset:576
  v_mfma_f32_32x32x16_bf16 v[32:47], v[16:19], v[104:107], v[32:47]
  s_waitcnt lgkmcnt(0)
  v_fma_f32 v72, -v4, v12, v72
  v_fma_f32 v73, -v4, v13, v73
  v_fma_f32 v74, -v4, v14, v74
  v_fma_f32 v75, -v4, v15, v75
  v_mfma_f32_32x32x16_bf16 v[48:63], v[20:23], v[104:107], v[48:63]
  s_barrier
  v_add_u32 v1, 0x4080, v1
  ds_read_b64_tr_b16 v[16:17], v1 offset:0
  ds_read_b64_tr_b16 v[18:19], v1 offset:512
  ds_read_b64_tr_b16 v[20:21], v1 offset:32
  ds_read_b64_tr_b16 v[22:23], v1 offset:544
  ds_read_b128 v[12:15], v8 offset:608
  s_waitcnt lgkmcnt(0)
  v_fma_f32 v76, -v4, v12, v76
  v_fma_f32 v77, -v4, v13, v77
  v_fma_f32 v78, -v4, v14, v78
  v_fma_f32 v79, -v4, v15, v79
  v_mul_f32 v64, v64, v72
  v_mul_f32 v65, v65, v73
  v_mul_f32 v66, v66, v74
  v_mul_f32 v67, v67, v75
  v_mul_f32 v68, v68, v76
  v_mul_f32 v69, v69, v77
  v_mul_f32 v70, v70, v78
  v_mul_f32 v71, v71, v79
  v_mfma_f32_32x32x16_bf16 v[32:47], v[24:27], v[108:111], v[32:47]
  v_mul_f32 v64, v9, v64
  v_mul_f32 v65, v9, v65
  v_mul_f32 v66, v9, v66
  v_mul_f32 v67, v9, v67
  v_mfma_f32_32x32x16_bf16 v[48:63], v[28:31], v[108:111], v[48:63]
  s_add_u32 s66, s75, 9
  s_cmp_ge_u32 s66, 10
  s_cselect_b32 s67, 10, 0
  s_sub_u32 s66, s66, s67
  s_mul_i32 s66, s66, 221184
  s_lshl_b32 s64, s58, 7
  s_add_u32 s64, s64, s66
  s_add_u32 s64, s64, 128
  s_add_u32 m0, s70, 34816
  s_nop 0
  buffer_load_dwordx4 v2, s[32:35], s64 offen lds
  s_add_u32 s66, s75, 9
  s_cmp_ge_u32 s66, 10
  s_cselect_b32 s67, 10, 0
  s_sub_u32 s66, s66, s67
  s_mul_i32 s66, s66, 221184
  s_lshl_b32 s64, s58, 7
  s_add_u32 s64, s64, s66
  s_add_u32 s64, s64, 128
  s_add_u32 m0, s70, 43040
  s_nop 0
  buffer_load_dwordx4 v2, s[36:39], s64 offen lds
  ds_read_b64_tr_b16 v[24:25], v1 offset:2048
  ds_read_b64_tr_b16 v[26:27], v1 offset:2560
  ds_read_b64_tr_b16 v[28:29], v1 offset:2080
  ds_read_b64_tr_b16 v[30:31], v1 offset:2592
  v_mul_f32 v68, v9, v68
  v_mul_f32 v69, v9, v69
  v_mul_f32 v70, v9, v70
  v_mul_f32 v71, v9, v71
  v_cvt_pk_bf16_f32 v72, v64, v65
  v_cvt_pk_bf16_f32 v73, v66, v67
  v_cvt_pk_bf16_f32 v74, v68, v69
  v_cvt_pk_bf16_f32 v75, v70, v71
  s_nop 0
  v_permlane32_swap_b32 v72, v74
  v_permlane32_swap_b32 v73, v75
  buffer_store_dwordx4 v[72:75], v6, s[48:51], s76 offen sc1
  v_mfma_f32_32x32x16_bf16 v[32:47], v[16:19], v[112:115], v[32:47]
  s_mov_b32 s50, 24100864
  s_add_u32 s66, s58, 0
  s_lshl_b32 s66, s66, 2
  s_lshl_b32 s67, s54, 1
  s_add_u32 s66, s66, s67
  s_add_u32 s66, s66, 1
  s_lshr_b32 s76, s66, 2
  s_mul_i32 s76, s76, 10240
  s_and_b32 s67, s66, 3
  s_lshl_b32 s67, s67, 11
  s_add_u32 s76, s76, s67
  v_mul_f32 v9, v5, v5
  s_lshl_b32 s67, s54, 8
  v_lshlrev_b32 v8, 4, v7
  v_add_u32 v8, s67, v8
  v_mfma_f32_32x32x16_bf16 v[48:63], v[20:23], v[112:115], v[48:63]
  ds_read_b64_tr_b16 v[16:17], v1 offset:4096
  ds_read_b64_tr_b16 v[18:19], v1 offset:4608
  ds_read_b64_tr_b16 v[20:21], v1 offset:4128
  ds_read_b64_tr_b16 v[22:23], v1 offset:4640
  ds_read_b128 v[12:15], v8 offset:640
  s_waitcnt lgkmcnt(0)
  v_fma_f32 v80, -v4, v12, v80
  v_fma_f32 v81, -v4, v13, v81
  v_fma_f32 v82, -v4, v14, v82
  v_fma_f32 v83, -v4, v15, v83
  ds_read_b128 v[12:15], v8 offset:672
  s_waitcnt lgkmcnt(0)
  v_fma_f32 v84, -v4, v12, v84
  v_fma_f32 v85, -v4, v13, v85
  v_fma_f32 v86, -v4, v14, v86
  v_fma_f32 v87, -v4, v15, v87
  ds_read_b128 v[12:15], v8 offset:704
  v_mfma_f32_32x32x16_bf16 v[32:47], v[24:27], v[116:119], v[32:47]
  s_waitcnt lgkmcnt(0)
  v_fma_f32 v88, -v4, v12, v88
  v_fma_f32 v89, -v4, v13, v89
  v_fma_f32 v90, -v4, v14, v90
  v_fma_f32 v91, -v4, v15, v91
  v_mfma_f32_32x32x16_bf16 v[48:63], v[28:31], v[116:119], v[48:63]
  ds_read_b64_tr_b16 v[24:25], v1 offset:6144
  ds_read_b64_tr_b16 v[26:27], v1 offset:6656
  ds_read_b64_tr_b16 v[28:29], v1 offset:6176
  ds_read_b64_tr_b16 v[30:31], v1 offset:6688
  ds_read_b128 v[12:15], v8 offset:736
  s_waitcnt lgkmcnt(0)
  v_fma_f32 v92, -v4, v12, v92
  v_fma_f32 v93, -v4, v13, v93
  v_fma_f32 v94, -v4, v14, v94
  v_fma_f32 v95, -v4, v15, v95
  v_mul_f32 v80, v80, v88
  v_mul_f32 v81, v81, v89
  v_mul_f32 v82, v82, v90
  v_mul_f32 v83, v83, v91
  v_mul_f32 v84, v84, v92
  v_mul_f32 v85, v85, v93
  v_mul_f32 v86, v86, v94
  v_mul_f32 v87, v87, v95
  v_mfma_f32_32x32x16_bf16 v[32:47], v[16:19], v[120:123], v[32:47]
  v_mul_f32 v80, v9, v80
  v_mul_f32 v81, v9, v81
  v_mul_f32 v82, v9, v82
  v_mul_f32 v83, v9, v83
  v_mfma_f32_32x32x16_bf16 v[48:63], v[20:23], v[120:123], v[48:63]
  s_barrier
  v_add_u32 v1, 0x4080, v1
  ds_read_b64_tr_b16 v[16:17], v1 offset:0
  ds_read_b64_tr_b16 v[18:19], v1 offset:512
  ds_read_b64_tr_b16 v[20:21], v1 offset:32
  ds_read_b64_tr_b16 v[22:23], v1 offset:544
  v_mul_f32 v84, v9, v84
  v_mul_f32 v85, v9, v85
  v_mul_f32 v86, v9, v86
  v_mul_f32 v87, v9, v87
  v_cvt_pk_bf16_f32 v88, v80, v81
  v_cvt_pk_bf16_f32 v89, v82, v83
  v_cvt_pk_bf16_f32 v90, v84, v85
  v_cvt_pk_bf16_f32 v91, v86, v87
  s_nop 0
  v_permlane32_swap_b32 v88, v90
  v_permlane32_swap_b32 v89, v91
  buffer_store_dwordx4 v[88:91], v6, s[48:51], s76 offen sc1
  v_mfma_f32_32x32x16_bf16 v[32:47], v[24:27], v[124:127], v[32:47]
  v_mfma_f32_32x32x16_bf16 v[48:63], v[28:31], v[124:127], v[48:63]
  ds_read_b64_tr_b16 v[24:25], v1 offset:2048
  ds_read_b64_tr_b16 v[26:27], v1 offset:2560
  ds_read_b64_tr_b16 v[28:29], v1 offset:2080
  ds_read_b64_tr_b16 v[30:31], v1 offset:2592
  s_waitcnt lgkmcnt(4)
  v_mfma_f32_32x32x16_bf16 v[32:47], v[16:19], v[128:131], v[32:47]
  v_mfma_f32_32x32x16_bf16 v[48:63], v[20:23], v[128:131], v[48:63]
  ds_read_b64_tr_b16 v[16:17], v1 offset:4096
  ds_read_b64_tr_b16 v[18:19], v1 offset:4608
  ds_read_b64_tr_b16 v[20:21], v1 offset:4128
  ds_read_b64_tr_b16 v[22:23], v1 offset:4640
  s_waitcnt lgkmcnt(4)
  v_mfma_f32_32x32x16_bf16 v[32:47], v[24:27], v[132:135], v[32:47]
  v_mfma_f32_32x32x16_bf16 v[48:63], v[28:31], v[132:135], v[48:63]
  ds_read_b64_tr_b16 v[24:25], v1 offset:6144
  ds_read_b64_tr_b16 v[26:27], v1 offset:6656
  ds_read_b64_tr_b16 v[28:29], v1 offset:6176
  ds_read_b64_tr_b16 v[30:31], v1 offset:6688
  s_waitcnt lgkmcnt(4)
  v_mfma_f32_32x32x16_bf16 v[32:47], v[16:19], v[136:139], v[32:47]
  v_mfma_f32_32x32x16_bf16 v[48:63], v[20:23], v[136:139], v[48:63]
  s_waitcnt lgkmcnt(0)
  s_barrier
  v_add_u32 v1, 0x4080, v1
  ds_read_b64_tr_b16 v[16:17], v1 offset:0
  ds_read_b64_tr_b16 v[18:19], v1 offset:512
  ds_read_b64_tr_b16 v[20:21], v1 offset:32
  ds_read_b64_tr_b16 v[22:23], v1 offset:544
  s_lshr_b32 s84, s60, 5
  s_and_b32 s85, s60, 31
  v_mbcnt_lo_u32_b32 v64, -1, 0
  v_mbcnt_hi_u32_b32 v64, -1, v64
  s_lshl_b32 s64, s84, 5
  s_sub_i32 s64, s64, 32
  v_add_u32 v64, s64, v64
  v_cmp_le_i32 vcc, 0, v64
  v_mov_b32 v65, 0
  s_nop 0
  v_cndmask_b32 v65, v65, 1, vcc
  v_max_i32 v64, 0, v64
  v_lshlrev_b32 v64, 7, v64
  v_add_u32 v64, 24068096, v64
  buffer_load_dword v66, v64, s[40:43], 0 offen sc1
  v_mfma_f32_32x32x16_bf16 v[32:47], v[24:27], v[140:143], v[32:47]
  v_mfma_f32_32x32x16_bf16 v[48:63], v[28:31], v[140:143], v[48:63]
  ds_read_b64_tr_b16 v[24:25], v1 offset:2048
  ds_read_b64_tr_b16 v[26:27], v1 offset:2560
  ds_read_b64_tr_b16 v[28:29], v1 offset:2080
  ds_read_b64_tr_b16 v[30:31], v1 offset:2592
  s_waitcnt lgkmcnt(4)
  v_mfma_f32_32x32x16_bf16 v[32:47], v[16:19], v[144:147], v[32:47]
  v_mfma_f32_32x32x16_bf16 v[48:63], v[20:23], v[144:147], v[48:63]
  ds_read_b64_tr_b16 v[16:17], v1 offset:4096
  ds_read_b64_tr_b16 v[18:19], v1 offset:4608
  ds_read_b64_tr_b16 v[20:21], v1 offset:4128
  ds_read_b64_tr_b16 v[22:23], v1 offset:4640
  s_waitcnt lgkmcnt(4)
  v_mfma_f32_32x32x16_bf16 v[32:47], v[24:27], v[148:151], v[32:47]
  v_mfma_f32_32x32x16_bf16 v[48:63], v[28:31], v[148:151], v[48:63]
  ds_read_b64_tr_b16 v[24:25], v1 offset:6144
  ds_read_b64_tr_b16 v[26:27], v1 offset:6656
  ds_read_b64_tr_b16 v[28:29], v1 offset:6176
  ds_read_b64_tr_b16 v[30:31], v1 offset:6688
  s_waitcnt lgkmcnt(4)
  v_mfma_f32_32x32x16_bf16 v[32:47], v[16:19], v[152:155], v[32:47]
  v_mfma_f32_32x32x16_bf16 v[48:63], v[20:23], v[152:155], v[48:63]
  s_waitcnt lgkmcnt(0)
  s_barrier
  v_add_u32 v1, 0x4080, v1
  ds_read_b64_tr_b16 v[16:17], v1 offset:0
  ds_read_b64_tr_b16 v[18:19], v1 offset:512
  ds_read_b64_tr_b16 v[20:21], v1 offset:32
  ds_read_b64_tr_b16 v[22:23], v1 offset:544
  v_mfma_f32_32x32x16_bf16 v[32:47], v[24:27], v[156:159], v[32:47]
  v_mfma_f32_32x32x16_bf16 v[48:63], v[28:31], v[156:159], v[48:63]
  ds_read_b64_tr_b16 v[24:25], v1 offset:2048
  ds_read_b64_tr_b16 v[26:27], v1 offset:2560
  ds_read_b64_tr_b16 v[28:29], v1 offset:2080
  ds_read_b64_tr_b16 v[30:31], v1 offset:2592
  s_waitcnt lgkmcnt(4)
  v_mfma_f32_32x32x16_bf16 v[32:47], v[16:19], v[160:163], v[32:47]
  v_mfma_f32_32x32x16_bf16 v[48:63], v[20:23], v[160:163], v[48:63]
  ds_read_b64_tr_b16 v[16:17], v1 offset:4096
  ds_read_b64_tr_b16 v[18:19], v1 offset:4608
  ds_read_b64_tr_b16 v[20:21], v1 offset:4128
  ds_read_b64_tr_b16 v[22:23], v1 offset:4640
  s_waitcnt lgkmcnt(4)
  v_mfma_f32_32x32x16_bf16 v[32:47], v[24:27], v[164:167], v[32:47]
  v_mfma_f32_32x32x16_bf16 v[48:63], v[28:31], v[164:167], v[48:63]
  ds_read_b64_tr_b16 v[24:25], v1 offset:6144
  ds_read_b64_tr_b16 v[26:27], v1 offset:6656
  ds_read_b64_tr_b16 v[28:29], v1 offset:6176
  ds_read_b64_tr_b16 v[30:31], v1 offset:6688
  s_waitcnt lgkmcnt(4)
  v_mfma_f32_32x32x16_bf16 v[32:47], v[16:19], v[168:171], v[32:47]
  v_mfma_f32_32x32x16_bf16 v[48:63], v[20:23], v[168:171], v[48:63]
  s_waitcnt lgkmcnt(0)
  s_barrier
  v_add_u32 v1, 0x4080, v1
  ds_read_b64_tr_b16 v[16:17], v1 offset:0
  ds_read_b64_tr_b16 v[18:19], v1 offset:512
  ds_read_b64_tr_b16 v[20:21], v1 offset:32
  ds_read_b64_tr_b16 v[22:23], v1 offset:544
  v_mfma_f32_32x32x16_bf16 v[32:47], v[24:27], v[172:175], v[32:47]
  v_mfma_f32_32x32x16_bf16 v[48:63], v[28:31], v[172:175], v[48:63]
  ds_read_b64_tr_b16 v[24:25], v1 offset:2048
  ds_read_b64_tr_b16 v[26:27], v1 offset:2560
  ds_read_b64_tr_b16 v[28:29], v1 offset:2080
  ds_read_b64_tr_b16 v[30:31], v1 offset:2592
  s_waitcnt lgkmcnt(4)
  v_mfma_f32_32x32x16_bf16 v[32:47], v[16:19], v[176:179], v[32:47]
  v_mfma_f32_32x32x16_bf16 v[48:63], v[20:23], v[176:179], v[48:63]
  ds_read_b64_tr_b16 v[16:17], v1 offset:4096
  ds_read_b64_tr_b16 v[18:19], v1 offset:4608
  ds_read_b64_tr_b16 v[20:21], v1 offset:4128
  ds_read_b64_tr_b16 v[22:23], v1 offset:4640
  s_waitcnt lgkmcnt(4)
  v_mfma_f32_32x32x16_bf16 v[32:47], v[24:27], v[180:183], v[32:47]
  v_mfma_f32_32x32x16_bf16 v[48:63], v[28:31], v[180:183], v[48:63]
  ds_read_b64_tr_b16 v[24:25], v1 offset:6144
  ds_read_b64_tr_b16 v[26:27], v1 offset:6656
  ds_read_b64_tr_b16 v[28:29], v1 offset:6176
  ds_read_b64_tr_b16 v[30:31], v1 offset:6688
  s_waitcnt lgkmcnt(4)
  v_mfma_f32_32x32x16_bf16 v[32:47], v[16:19], v[184:187], v[32:47]
  v_mfma_f32_32x32x16_bf16 v[48:63], v[20:23], v[184:187], v[48:63]
  s_waitcnt vmcnt(1)
  s_waitcnt lgkmcnt(0)
  s_barrier
  v_add_u32 v1, 0x4080, v1
  ds_read_b64_tr_b16 v[16:17], v1 offset:0
  ds_read_b64_tr_b16 v[18:19], v1 offset:512
  ds_read_b64_tr_b16 v[20:21], v1 offset:32
  ds_read_b64_tr_b16 v[22:23], v1 offset:544
  s_cmp_eq_u32 s52, 0
  s_cbranch_scc0 L_pub2_2390
  v_mov_b32 v12, 2
  v_mov_b32 v13, 2
  v_mov_b32 v14, 2
  v_mov_b32 v15, 2
  v_mbcnt_lo_u32_b32 v10, -1, 0
  v_lshlrev_b32 v10, 4, v10
  s_lshl_b32 s64, s60, 7
  s_add_u32 s64, s64, 24068096
  s_mov_b64 s[72:73], exec
  s_mov_b64 exec, 0xff
  buffer_store_dwordx4 v[12:15], v10, s[40:43], s64 offen sc1
  s_mov_b64 exec, s[72:73]
L_pub2_2390:
  v_mfma_f32_32x32x16_bf16 v[32:47], v[24:27], v[188:191], v[32:47]
  v_mfma_f32_32x32x16_bf16 v[48:63], v[28:31], v[188:191], v[48:63]
  ds_read_b64_tr_b16 v[24:25], v1 offset:2048
  ds_read_b64_tr_b16 v[26:27], v1 offset:2560
  ds_read_b64_tr_b16 v[28:29], v1 offset:2080
  ds_read_b64_tr_b16 v[30:31], v1 offset:2592
  s_waitcnt lgkmcnt(4)
  v_mfma_f32_32x32x16_bf16 v[32:47], v[16:19], v[192:195], v[32:47]
  v_mfma_f32_32x32x16_bf16 v[48:63], v[20:23], v[192:195], v[48:63]
  ds_read_b64_tr_b16 v[16:17], v1 offset:4096
  ds_read_b64_tr_b16 v[18:19], v1 offset:4608
  ds_read_b64_tr_b16 v[20:21], v1 offset:4128
  ds_read_b64_tr_b16 v[22:23], v1 offset:4640
  s_waitcnt lgkmcnt(4)
  v_mfma_f32_32x32x16_bf16 v[32:47], v[24:27], v[196:199], v[32:47]
  v_mfma_f32_32x32x16_bf16 v[48:63], v[28:31], v[196:199], v[48:63]
  ds_read_b64_tr_b16 v[24:25], v1 offset:6144
  ds_read_b64_tr_b16 v[26:27], v1 offset:6656
  ds_read_b64_tr_b16 v[28:29], v1 offset:6176
  ds_read_b64_tr_b16 v[30:31], v1 offset:6688
  s_waitcnt lgkmcnt(4)
  v_mfma_f32_32x32x16_bf16 v[32:47], v[16:19], v[200:203], v[32:47]
  v_mfma_f32_32x32x16_bf16 v[48:63], v[20:23], v[200:203], v[48:63]
  s_waitcnt lgkmcnt(0)
  s_barrier
  v_add_u32 v1, 0xfffdfc00, v1
  ds_read_b64_tr_b16 v[16:17], v1 offset:0
  ds_read_b64_tr_b16 v[18:19], v1 offset:512
  ds_read_b64_tr_b16 v[20:21], v1 offset:32
  ds_read_b64_tr_b16 v[22:23], v1 offset:544
  s_waitcnt vmcnt(0)
  s_cmp_eq_u32 s52, 0
  s_cbranch_scc0 L_kvf_ok
  s_mov_b32 s79, 0
  s_branch L_wfc1
L_wf1:
  buffer_load_dword v66, v64, s[40:43], 0 offen sc1
  s_waitcnt vmcnt(0)
L_wfc1:
  v_cmp_lt_u32 vcc, v66, v65
  s_nop 0
  s_cbranch_vccz L_wfok1
L_wfs1:
  s_sleep 8
  s_add_u32 s79, s79, 1
  s_cmp_lt_u32 s79, 0x40000
  s_cbranch_scc1 L_wf1
L_wfok1:
L_kvf_ok:
  v_mfma_f32_32x32x16_bf16 v[32:47], v[24:27], v[204:207], v[32:47]
  v_mfma_f32_32x32x16_bf16 v[48:63], v[28:31], v[204:207], v[48:63]
  ds_read_b64_tr_b16 v[24:25], v1 offset:2048
  ds_read_b64_tr_b16 v[26:27], v1 offset:2560
  ds_read_b64_tr_b16 v[28:29], v1 offset:2080
  ds_read_b64_tr_b16 v[30:31], v1 offset:2592
  s_waitcnt lgkmcnt(4)
  v_mfma_f32_32x32x16_bf16 v[32:47], v[16:19], v[208:211], v[32:47]
  v_mfma_f32_32x32x16_bf16 v[48:63], v[20:23], v[208:211], v[48:63]
  ds_read_b64_tr_b16 v[16:17], v1 offset:4096
  ds_read_b64_tr_b16 v[18:19], v1 offset:4608
  ds_read_b64_tr_b16 v[20:21], v1 offset:4128
  ds_read_b64_tr_b16 v[22:23], v1 offset:4640
  s_waitcnt lgkmcnt(4)
  v_mfma_f32_32x32x16_bf16 v[32:47], v[24:27], v[212:215], v[32:47]
  v_mfma_f32_32x32x16_bf16 v[48:63], v[28:31], v[212:215], v[48:63]
  ds_read_b64_tr_b16 v[24:25], v1 offset:6144
  ds_read_b64_tr_b16 v[26:27], v1 offset:6656
  ds_read_b64_tr_b16 v[28:29], v1 offset:6176
  ds_read_b64_tr_b16 v[30:31], v1 offset:6688
  s_waitcnt lgkmcnt(4)
  v_mfma_f32_32x32x16_bf16 v[32:47], v[16:19], v[216:219], v[32:47]
  v_mfma_f32_32x32x16_bf16 v[48:63], v[20:23], v[216:219], v[48:63]
  s_waitcnt lgkmcnt(0)
  s_barrier
  v_add_u32 v1, 0x4080, v1
  ds_read_b64_tr_b16 v[16:17], v1 offset:0
  ds_read_b64_tr_b16 v[18:19], v1 offset:512
  ds_read_b64_tr_b16 v[20:21], v1 offset:32
  ds_read_b64_tr_b16 v[22:23], v1 offset:544
  v_mbcnt_lo_u32_b32 v11, -1, 0
  v_mbcnt_hi_u32_b32 v11, -1, v11
  v_lshlrev_b32 v11, 4, v11
  s_lshl_b32 s76, s84, 11
  s_mul_i32 s86, s85, 81920
  s_add_u32 s87, s86, s76
  s_add_u32 s86, s87, 0x27f800
  s_add_u32 s64, s52, 0
  s_lshr_b32 s65, s64, 2
  s_and_b32 s66, s64, 3
  s_lshl_b32 s66, s66, 10
  s_mul_i32 s67, s65, 16384
  s_add_u32 s67, s67, s66
  s_add_u32 s67, s67, s86
  s_mul_i32 s65, s65, 4128
  s_add_u32 s65, s65, s66
  s_add_u32 m0, s65, 108032
  s_nop 0
  buffer_load_dwordx4 v11, s[40:43], s67 offen sc1 lds
  v_mfma_f32_32x32x16_bf16 v[32:47], v[24:27], v[220:223], v[32:47]
  s_add_u32 s64, s52, 8
  s_lshr_b32 s65, s64, 2
  s_and_b32 s66, s64, 3
  s_lshl_b32 s66, s66, 10
  s_mul_i32 s67, s65, 16384
  s_add_u32 s67, s67, s66
  s_add_u32 s67, s67, s86
  s_mul_i32 s65, s65, 4128
  s_add_u32 s65, s65, s66
  s_add_u32 m0, s65, 108032
  s_nop 0
  buffer_load_dwordx4 v11, s[40:43], s67 offen sc1 lds
  v_mfma_f32_32x32x16_bf16 v[48:63], v[28:31], v[220:223], v[48:63]
  ds_read_b64_tr_b16 v[24:25], v1 offset:2048
  ds_read_b64_tr_b16 v[26:27], v1 offset:2560
  ds_read_b64_tr_b16 v[28:29], v1 offset:2080
  ds_read_b64_tr_b16 v[30:31], v1 offset:2592
  s_add_u32 s64, s52, 16
  s_cmp_ge_u32 s64, 20
  s_cselect_b32 s65, 20, 0
  s_cselect_b32 s68, 2621440, 0
  s_cselect_b32 s69, 20640, 0
  s_sub_u32 s64, s64, s65
  s_lshr_b32 s65, s64, 2
  s_and_b32 s66, s64, 3
  s_lshl_b32 s66, s66, 10
  s_mul_i32 s67, s65, 16384
  s_add_u32 s67, s67, s66
  s_add_u32 s67, s67, s86
  s_mul_i32 s65, s65, 4128
  s_add_u32 s65, s65, s66
  s_add_u32 s67, s67, s68
  s_add_u32 s65, s65, s69
  s_add_u32 m0, s65, 108032
  s_nop 0
  buffer_load_dwordx4 v11, s[40:43], s67 offen sc1 lds
  s_waitcnt lgkmcnt(4)
  v_mfma_f32_32x32x16_bf16 v[32:47], v[16:19], v[224:227], v[32:47]
  s_add_u32 s64, s52, 24
  s_sub_u32 s64, s64, 20
  s_lshr_b32 s65, s64, 2
  s_and_b32 s66, s64, 3
  s_lshl_b32 s66, s66, 10
  s_mul_i32 s67, s65, 16384
  s_add_u32 s67, s67, s66
  s_add_u32 s67, s67, s86
  s_mul_i32 s65, s65, 4128
  s_add_u32 s65, s65, s66
  s_add_u32 s67, s67, 2621440
  s_add_u32 m0, s65, 128672
  s_nop 0
  buffer_load_dwordx4 v11, s[40:43], s67 offen sc1 lds
  v_mfma_f32_32x32x16_bf16 v[48:63], v[20:23], v[224:227], v[48:63]
  ds_read_b64_tr_b16 v[16:17], v1 offset:4096
  ds_read_b64_tr_b16 v[18:19], v1 offset:4608
  ds_read_b64_tr_b16 v[20:21], v1 offset:4128
  ds_read_b64_tr_b16 v[22:23], v1 offset:4640
  s_add_u32 s64, s52, 32
  s_sub_u32 s64, s64, 20
  s_lshr_b32 s65, s64, 2
  s_and_b32 s66, s64, 3
  s_lshl_b32 s66, s66, 10
  s_mul_i32 s67, s65, 16384
  s_add_u32 s67, s67, s66
  s_add_u32 s67, s67, s86
  s_mul_i32 s65, s65, 4128
  s_add_u32 s65, s65, s66
  s_add_u32 s67, s67, 2621440
  s_add_u32 m0, s65, 128672
  s_nop 0
  buffer_load_dwordx4 v11, s[40:43], s67 offen sc1 lds
  s_waitcnt lgkmcnt(4)
  v_mfma_f32_32x32x16_bf16 v[32:47], v[24:27], v[228:231], v[32:47]
  s_add_u32 s64, s52, 40
  s_sub_u32 s64, s64, 40
  s_min_u32 s64, s64, 9
  s_lshr_b32 s65, s64, 1
  s_and_b32 s66, s64, 1
  s_lshl_b32 s66, s66, 10
  s_mul_i32 s67, s65, 16384
  s_add_u32 s67, s67, s66
  s_add_u32 s67, s67, s87
  s_lshl_b32 s65, s65, 11
  s_add_u32 s65, s65, s66
  s_add_u32 m0, s65, 149312
  s_nop 0
  buffer_load_dwordx4 v11, s[40:43], s67 offen sc1 lds
  v_mfma_f32_32x32x16_bf16 v[48:63], v[28:31], v[228:231], v[48:63]
  ds_read_b64_tr_b16 v[24:25], v1 offset:6144
  ds_read_b64_tr_b16 v[26:27], v1 offset:6656
  ds_read_b64_tr_b16 v[28:29], v1 offset:6176
  ds_read_b64_tr_b16 v[30:31], v1 offset:6688
  s_add_u32 s64, s52, 48
  s_sub_u32 s64, s64, 40
  s_min_u32 s64, s64, 9
  s_lshr_b32 s65, s64, 1
  s_and_b32 s66, s64, 1
  s_lshl_b32 s66, s66, 10
  s_mul_i32 s67, s65, 16384
  s_add_u32 s67, s67, s66
  s_add_u32 s67, s67, s87
  s_lshl_b32 s65, s65, 11
  s_add_u32 s65, s65, s66
  s_add_u32 m0, s65, 149312
  s_nop 0
  buffer_load_dwordx4 v11, s[40:43], s67 offen sc1 lds
  s_waitcnt lgkmcnt(4)
  v_mfma_f32_32x32x16_bf16 v[32:47], v[16:19], v[232:235], v[32:47]
  v_mfma_f32_32x32x16_bf16 v[48:63], v[20:23], v[232:235], v[48:63]
  s_waitcnt lgkmcnt(0)
  s_barrier
  v_add_u32 v1, 0x4080, v1
  ds_read_b64_tr_b16 v[16:17], v1 offset:0
  ds_read_b64_tr_b16 v[18:19], v1 offset:512
  ds_read_b64_tr_b16 v[20:21], v1 offset:32
  ds_read_b64_tr_b16 v[22:23], v1 offset:544
  v_mfma_f32_32x32x16_bf16 v[32:47], v[24:27], v[236:239], v[32:47]
  v_mfma_f32_32x32x16_bf16 v[48:63], v[28:31], v[236:239], v[48:63]
  ds_read_b64_tr_b16 v[24:25], v1 offset:2048
  ds_read_b64_tr_b16 v[26:27], v1 offset:2560
  ds_read_b64_tr_b16 v[28:29], v1 offset:2080
  ds_read_b64_tr_b16 v[30:31], v1 offset:2592
  s_waitcnt lgkmcnt(4)
  v_mfma_f32_32x32x16_bf16 v[32:47], v[16:19], v[240:243], v[32:47]
  v_mfma_f32_32x32x16_bf16 v[48:63], v[20:23], v[240:243], v[48:63]
  ds_read_b64_tr_b16 v[16:17], v1 offset:4096
  ds_read_b64_tr_b16 v[18:19], v1 offset:4608
  ds_read_b64_tr_b16 v[20:21], v1 offset:4128
  ds_read_b64_tr_b16 v[22:23], v1 offset:4640
  s_waitcnt lgkmcnt(4)
  v_mfma_f32_32x32x16_bf16 v[32:47], v[24:27], v[244:247], v[32:47]
  v_mfma_f32_32x32x16_bf16 v[48:63], v[28:31], v[244:247], v[48:63]
  ds_read_b64_tr_b16 v[24:25], v1 offset:6144
  ds_read_b64_tr_b16 v[26:27], v1 offset:6656
  ds_read_b64_tr_b16 v[28:29], v1 offset:6176
  ds_read_b64_tr_b16 v[30:31], v1 offset:6688
  s_waitcnt lgkmcnt(4)
  v_mfma_f32_32x32x16_bf16 v[32:47], v[16:19], v[248:251], v[32:47]
  v_mfma_f32_32x32x16_bf16 v[48:63], v[20:23], v[248:251], v[48:63]
  s_waitcnt lgkmcnt(0)
  v_mfma_f32_32x32x16_bf16 v[32:47], v[24:27], v[252:255], v[32:47]
  v_mfma_f32_32x32x16_bf16 v[48:63], v[28:31], v[252:255], v[48:63]
  s_mov_b32 s50, 24100864
  s_add_u32 s66, s58, 1
  s_lshl_b32 s66, s66, 2
  s_lshl_b32 s67, s54, 1
  s_add_u32 s66, s66, s67
  s_add_u32 s66, s66, 0
  s_lshr_b32 s76, s66, 2
  s_mul_i32 s76, s76, 10240
  s_and_b32 s67, s66, 3
  s_lshl_b32 s67, s67, 11
  s_add_u32 s76, s76, s67
  v_mul_f32 v9, v5, v5
  s_lshl_b32 s67, s54, 8
  v_lshlrev_b32 v8, 4, v7
  v_add_u32 v8, s67, v8
  ds_read_b128 v[12:15], v8 offset:1024
  s_waitcnt lgkmcnt(0)
  v_fma_f32 v32, -v4, v12, v32
  v_fma_f32 v33, -v4, v13, v33
  v_fma_f32 v34, -v4, v14, v34
  v_fma_f32 v35, -v4, v15, v35
  ds_read_b128 v[12:15], v8 offset:1056
  s_waitcnt lgkmcnt(0)
  v_fma_f32 v36, -v4, v12, v36
  v_fma_f32 v37, -v4, v13, v37
  v_fma_f32 v38, -v4, v14, v38
  v_fma_f32 v39, -v4, v15, v39
  ds_read_b128 v[12:15], v8 offset:1088
  s_waitcnt lgkmcnt(0)
  v_fma_f32 v40, -v4, v12, v40
  v_fma_f32 v41, -v4, v13, v41
  v_fma_f32 v42, -v4, v14, v42
  v_fma_f32 v43, -v4, v15, v43
  ds_read_b128 v[12:15], v8 offset:1120
  s_waitcnt lgkmcnt(0)
  v_fma_f32 v44, -v4, v12, v44
  v_fma_f32 v45, -v4, v13, v45
  v_fma_f32 v46, -v4, v14, v46
  v_fma_f32 v47, -v4, v15, v47
  v_mul_f32 v32, v32, v40
  v_mul_f32 v33, v33, v41
  v_mul_f32 v34, v34, v42
  v_mul_f32 v35, v35, v43
  v_mul_f32 v36, v36, v44
  v_mul_f32 v37, v37, v45
  v_mul_f32 v38, v38, v46
  v_mul_f32 v39, v39, v47
  v_mul_f32 v32, v9, v32
  v_mul_f32 v33, v9, v33
  v_mul_f32 v34, v9, v34
  v_mul_f32 v35, v9, v35
  v_mul_f32 v36, v9, v36
  v_mul_f32 v37, v9, v37
  v_mul_f32 v38, v9, v38
  v_mul_f32 v39, v9, v39
  v_cvt_pk_bf16_f32 v40, v32, v33
  v_cvt_pk_bf16_f32 v41, v34, v35
  v_cvt_pk_bf16_f32 v42, v36, v37
  v_cvt_pk_bf16_f32 v43, v38, v39
  s_nop 0
  v_permlane32_swap_b32 v40, v42
  v_permlane32_swap_b32 v41, v43
  buffer_store_dwordx4 v[40:43], v6, s[48:51], s76 offen sc1
  s_mov_b32 s50, 24100864
  s_add_u32 s66, s58, 1
  s_lshl_b32 s66, s66, 2
  s_lshl_b32 s67, s54, 1
  s_add_u32 s66, s66, s67
  s_add_u32 s66, s66, 1
  s_lshr_b32 s76, s66, 2
  s_mul_i32 s76, s76, 10240
  s_and_b32 s67, s66, 3
  s_lshl_b32 s67, s67, 11
  s_add_u32 s76, s76, s67
  v_mul_f32 v9, v5, v5
  s_lshl_b32 s67, s54, 8
  v_lshlrev_b32 v8, 4, v7
  v_add_u32 v8, s67, v8
  ds_read_b128 v[12:15], v8 offset:1152
  s_waitcnt lgkmcnt(0)
  v_fma_f32 v48, -v4, v12, v48
  v_fma_f32 v49, -v4, v13, v49
  v_fma_f32 v50, -v4, v14, v50
  v_fma_f32 v51, -v4, v15, v51
  ds_read_b128 v[12:15], v8 offset:1184
  s_waitcnt lgkmcnt(0)
  v_fma_f32 v52, -v4, v12, v52
  v_fma_f32 v53, -v4, v13, v53
  v_fma_f32 v54, -v4, v14, v54
  v_fma_f32 v55, -v4, v15, v55
  ds_read_b128 v[12:15], v8 offset:1216
  s_waitcnt lgkmcnt(0)
  v_fma_f32 v56, -v4, v12, v56
  v_fma_f32 v57, -v4, v13, v57
  v_fma_f32 v58, -v4, v14, v58
  v_fma_f32 v59, -v4, v15, v59
  ds_read_b128 v[12:15], v8 offset:1248
  s_waitcnt lgkmcnt(0)
  v_fma_f32 v60, -v4, v12, v60
  v_fma_f32 v61, -v4, v13, v61
  v_fma_f32 v62, -v4, v14, v62
  v_fma_f32 v63, -v4, v15, v63
  v_mul_f32 v48, v48, v56
  v_mul_f32 v49, v49, v57
  v_mul_f32 v50, v50, v58
  v_mul_f32 v51, v51, v59
  v_mul_f32 v52, v52, v60
  v_mul_f32 v53, v53, v61
  v_mul_f32 v54, v54, v62
  v_mul_f32 v55, v55, v63
  v_mul_f32 v48, v9, v48
  v_mul_f32 v49, v9, v49
  v_mul_f32 v50, v9, v50
  v_mul_f32 v51, v9, v51
  v_mul_f32 v52, v9, v52
  v_mul_f32 v53, v9, v53
  v_mul_f32 v54, v9, v54
  v_mul_f32 v55, v9, v55
  v_cvt_pk_bf16_f32 v56, v48, v49
  v_cvt_pk_bf16_f32 v57, v50, v51
  v_cvt_pk_bf16_f32 v58, v52, v53
  v_cvt_pk_bf16_f32 v59, v54, v55
  s_nop 0
  v_permlane32_swap_b32 v56, v58
  v_permlane32_swap_b32 v57, v59
  buffer_store_dwordx4 v[56:59], v6, s[48:51], s76 offen sc1
  s_waitcnt vmcnt(2)
  s_branch L_p1_done
L_nop2:
  s_waitcnt lgkmcnt(4)
  v_mfma_f32_32x32x16_bf16 v[64:79], v[16:19], v[248:251], v[64:79]
  v_mfma_f32_32x32x16_bf16 v[80:95], v[20:23], v[248:251], v[80:95]
  s_waitcnt lgkmcnt(0)
  v_mfma_f32_32x32x16_bf16 v[64:79], v[24:27], v[252:255], v[64:79]
  v_mfma_f32_32x32x16_bf16 v[80:95], v[28:31], v[252:255], v[80:95]
  s_waitcnt lgkmcnt(0)
  s_mul_i32 s77, s55, 5
  s_add_u32 s77, s77, s56
  s_sub_u32 s77, s77, 10
  s_lshl_b32 s77, s77, 3
  s_add_u32 s77, s77, s52
  s_mov_b32 s80, s16
  s_and_b32 s81, s17, 0xffff
  s_mov_b32 s82, 2211840
  s_mov_b32 s83, 0x20000
  s_mov_b32 s84, s8
  s_and_b32 s85, s9, 0xffff
  s_mov_b32 s86, 819200
  s_mov_b32 s87, 0x20000
  v_lshlrev_b32 v100, 4, v0
  s_add_u32 s64, s77, 0
  s_min_u32 s64, s64, 3119
  s_mul_i32 s65, s64, 52429
  s_lshr_b32 s65, s65, 18
  s_mul_i32 s66, s65, 5
  s_sub_u32 s66, s64, s66
  s_mul_i32 s67, s65, 841
  s_lshr_b32 s67, s67, 16
  s_mul_i32 s68, s67, 78
  s_sub_u32 s68, s65, s68
  s_lshl_b32 s76, s66, 6
  v_add_u32 v96, s76, v0
  v_mul_u32_u24 v97, 6554, v96
  v_lshrrev_b32 v97, 16, v97
  v_mul_u32_u24 v98, 10, v97
  v_sub_u32 v96, v96, v98
  v_and_b32 v98, 19, v97
  v_bfe_u32 v99, v97, 3, 1
  v_lshl_add_u32 v98, v99, 2, v98
  v_bfe_u32 v99, v97, 2, 1
  v_lshl_add_u32 v98, v99, 3, v98
  s_lshl_b32 s76, s68, 5
  v_add_u32 v98, s76, v98
  v_subrev_u32 v97, 1728, v98
  v_mul_u32_u24 v99, 2731, v97
  v_lshrrev_b32 v99, 16, v99
  v_mul_u32_u24 v101, 24, v99
  v_sub_u32 v101, v97, v101
  v_mad_u32_u24 v99, v99, 20, v101
  v_cmp_gt_u32 vcc, 20, v101
  v_mov_b32 v97, 0x100000
  s_nop 0
  v_cndmask_b32 v99, v97, v99, vcc
  s_cmp_lt_u32 s68, 54
  s_cbranch_scc1 L_rp_h0
  v_mov_b32 v98, v99
L_rp_h0:
  s_movk_i32 s76, 1280
  v_mul_lo_u32 v98, v98, s76
  v_lshl_add_u32 v98, v96, 4, v98
  s_mul_i32 s76, s67, 160
  s_cmp_lt_u32 s68, 54
  s_cselect_b32 s48, s80, s84
  s_cselect_b32 s49, s81, s85
  s_cselect_b32 s50, s82, s86
  buffer_load_dwordx4 v[104:107], v98, s[48:51], s76 offen
  s_add_u32 s64, s77, 640
  s_min_u32 s64, s64, 3119
  s_mul_i32 s65, s64, 52429
  s_lshr_b32 s65, s65, 18
  s_mul_i32 s66, s65, 5
  s_sub_u32 s66, s64, s66
  s_mul_i32 s67, s65, 841
  s_lshr_b32 s67, s67, 16
  s_mul_i32 s68, s67, 78
  s_sub_u32 s68, s65, s68
  s_lshl_b32 s76, s66, 6
  v_add_u32 v96, s76, v0
  v_mul_u32_u24 v97, 6554, v96
  v_lshrrev_b32 v97, 16, v97
  v_mul_u32_u24 v98, 10, v97
  v_sub_u32 v96, v96, v98
  v_and_b32 v98, 19, v97
  v_bfe_u32 v99, v97, 3, 1
  v_lshl_add_u32 v98, v99, 2, v98
  v_bfe_u32 v99, v97, 2, 1
  v_lshl_add_u32 v98, v99, 3, v98
  s_lshl_b32 s76, s68, 5
  v_add_u32 v98, s76, v98
  v_subrev_u32 v97, 1728, v98
  v_mul_u32_u24 v99, 2731, v97
  v_lshrrev_b32 v99, 16, v99
  v_mul_u32_u24 v101, 24, v99
  v_sub_u32 v101, v97, v101
  v_mad_u32_u24 v99, v99, 20, v101
  v_cmp_gt_u32 vcc, 20, v101
  v_mov_b32 v97, 0x100000
  s_nop 0
  v_cndmask_b32 v99, v97, v99, vcc
  s_cmp_lt_u32 s68, 54
  s_cbranch_scc1 L_rp_h1
  v_mov_b32 v98, v99
L_rp_h1:
  s_movk_i32 s76, 1280
  v_mul_lo_u32 v98, v98, s76
  v_lshl_add_u32 v98, v96, 4, v98
  s_mul_i32 s76, s67, 160
  s_cmp_lt_u32 s68, 54
  s_cselect_b32 s48, s80, s84
  s_cselect_b32 s49, s81, s85
  s_cselect_b32 s50, s82, s86
  buffer_load_dwordx4 v[108:111], v98, s[48:51], s76 offen
  s_add_u32 s64, s77, 1280
  s_min_u32 s64, s64, 3119
  s_mul_i32 s65, s64, 52429
  s_lshr_b32 s65, s65, 18
  s_mul_i32 s66, s65, 5
  s_sub_u32 s66, s64, s66
  s_mul_i32 s67, s65, 841
  s_lshr_b32 s67, s67, 16
  s_mul_i32 s68, s67, 78
  s_sub_u32 s68, s65, s68
  s_lshl_b32 s76, s66, 6
  v_add_u32 v96, s76, v0
  v_mul_u32_u24 v97, 6554, v96
  v_lshrrev_b32 v97, 16, v97
  v_mul_u32_u24 v98, 10, v97
  v_sub_u32 v96, v96, v98
  v_and_b32 v98, 19, v97
  v_bfe_u32 v99, v97, 3, 1
  v_lshl_add_u32 v98, v99, 2, v98
  v_bfe_u32 v99, v97, 2, 1
  v_lshl_add_u32 v98, v99, 3, v98
  s_lshl_b32 s76, s68, 5
  v_add_u32 v98, s76, v98
  v_subrev_u32 v97, 1728, v98
  v_mul_u32_u24 v99, 2731, v97
  v_lshrrev_b32 v99, 16, v99
  v_mul_u32_u24 v101, 24, v99
  v_sub_u32 v101, v97, v101
  v_mad_u32_u24 v99, v99, 20, v101
  v_cmp_gt_u32 vcc, 20, v101
  v_mov_b32 v97, 0x100000
  s_nop 0
  v_cndmask_b32 v99, v97, v99, vcc
  s_cmp_lt_u32 s68, 54
  s_cbranch_scc1 L_rp_h2
  v_mov_b32 v98, v99
L_rp_h2:
  s_movk_i32 s76, 1280
  v_mul_lo_u32 v98, v98, s76
  v_lshl_add_u32 v98, v96, 4, v98
  s_mul_i32 s76, s67, 160
  s_cmp_lt_u32 s68, 54
  s_cselect_b32 s48, s80, s84
  s_cselect_b32 s49, s81, s85
  s_cselect_b32 s50, s82, s86
  buffer_load_dwordx4 v[112:115], v98, s[48:51], s76 offen
  s_add_u32 s64, s77, 1920
  s_min_u32 s64, s64, 3119
  s_mul_i32 s65, s64, 52429
  s_lshr_b32 s65, s65, 18
  s_mul_i32 s66, s65, 5
  s_sub_u32 s66, s64, s66
  s_mul_i32 s67, s65, 841
  s_lshr_b32 s67, s67, 16
  s_mul_i32 s68, s67, 78
  s_sub_u32 s68, s65, s68
  s_lshl_b32 s76, s66, 6
  v_add_u32 v96, s76, v0
  v_mul_u32_u24 v97, 6554, v96
  v_lshrrev_b32 v97, 16, v97
  v_mul_u32_u24 v98, 10, v97
  v_sub_u32 v96, v96, v98
  v_and_b32 v98, 19, v97
  v_bfe_u32 v99, v97, 3, 1
  v_lshl_add_u32 v98, v99, 2, v98
  v_bfe_u32 v99, v97, 2, 1
  v_lshl_add_u32 v98, v99, 3, v98
  s_lshl_b32 s76, s68, 5
  v_add_u32 v98, s76, v98
  v_subrev_u32 v97, 1728, v98
  v_mul_u32_u24 v99, 2731, v97
  v_lshrrev_b32 v99, 16, v99
  v_mul_u32_u24 v101, 24, v99
  v_sub_u32 v101, v97, v101
  v_mad_u32_u24 v99, v99, 20, v101
  v_cmp_gt_u32 vcc, 20, v101
  v_mov_b32 v97, 0x100000
  s_nop 0
  v_cndmask_b32 v99, v97, v99, vcc
  s_cmp_lt_u32 s68, 54
  s_cbranch_scc1 L_rp_h3
  v_mov_b32 v98, v99
L_rp_h3:
  s_movk_i32 s76, 1280
  v_mul_lo_u32 v98, v98, s76
  v_lshl_add_u32 v98, v96, 4, v98
  s_mul_i32 s76, s67, 160
  s_cmp_lt_u32 s68, 54
  s_cselect_b32 s48, s80, s84
  s_cselect_b32 s49, s81, s85
  s_cselect_b32 s50, s82, s86
  buffer_load_dwordx4 v[116:119], v98, s[48:51], s76 offen
  s_add_u32 s64, s77, 2560
  s_min_u32 s64, s64, 3119
  s_mul_i32 s65, s64, 52429
  s_lshr_b32 s65, s65, 18
  s_mul_i32 s66, s65, 5
  s_sub_u32 s66, s64, s66
  s_mul_i32 s67, s65, 841
  s_lshr_b32 s67, s67, 16
  s_mul_i32 s68, s67, 78
  s_sub_u32 s68, s65, s68
  s_lshl_b32 s76, s66, 6
  v_add_u32 v96, s76, v0
  v_mul_u32_u24 v97, 6554, v96
  v_lshrrev_b32 v97, 16, v97
  v_mul_u32_u24 v98, 10, v97
  v_sub_u32 v96, v96, v98
  v_and_b32 v98, 19, v97
  v_bfe_u32 v99, v97, 3, 1
  v_lshl_add_u32 v98, v99, 2, v98
  v_bfe_u32 v99, v97, 2, 1
  v_lshl_add_u32 v98, v99, 3, v98
  s_lshl_b32 s76, s68, 5
  v_add_u32 v98, s76, v98
  v_subrev_u32 v97, 1728, v98
  v_mul_u32_u24 v99, 2731, v97
  v_lshrrev_b32 v99, 16, v99
  v_mul_u32_u24 v101, 24, v99
  v_sub_u32 v101, v97, v101
  v_mad_u32_u24 v99, v99, 20, v101
  v_cmp_gt_u32 vcc, 20, v101
  v_mov_b32 v97, 0x100000
  s_nop 0
  v_cndmask_b32 v99, v97, v99, vcc
  s_cmp_lt_u32 s68, 54
  s_cbranch_scc1 L_rp_h4
  v_mov_b32 v98, v99
L_rp_h4:
  s_movk_i32 s76, 1280
  v_mul_lo_u32 v98, v98, s76
  v_lshl_add_u32 v98, v96, 4, v98
  s_mul_i32 s76, s67, 160
  s_cmp_lt_u32 s68, 54
  s_cselect_b32 s48, s80, s84
  s_cselect_b32 s49, s81, s85
  s_cselect_b32 s50, s82, s86
  buffer_load_dwordx4 v[120:123], v98, s[48:51], s76 offen
  s_mov_b32 s48, s22
  s_and_b32 s49, s23, 0xffff
  s_mov_b32 s50, 24100864
  s_mov_b32 s51, 0x20000
  s_waitcnt vmcnt(7)
  s_barrier
  s_cmp_eq_u32 s52, 0
  s_cbranch_scc0 L_pub1_3017
  v_mov_b32 v12, 1
  v_mov_b32 v13, 1
  v_mov_b32 v14, 1
  v_mov_b32 v15, 1
  v_mbcnt_lo_u32_b32 v10, -1, 0
  v_lshlrev_b32 v10, 4, v10
  s_lshl_b32 s64, s60, 7
  s_add_u32 s64, s64, 24068096
  s_mov_b64 s[72:73], exec
  s_mov_b64 exec, 0xff
  buffer_store_dwordx4 v[12:15], v10, s[40:43], s64 offen sc1
  s_mov_b64 exec, s[72:73]
L_pub1_3017:
  s_mov_b32 s50, 24100864
  s_add_u32 s66, s58, 0
  s_lshl_b32 s66, s66, 2
  s_lshl_b32 s67, s54, 1
  s_add_u32 s66, s66, s67
  s_add_u32 s66, s66, 0
  s_lshr_b32 s76, s66, 2
  s_mul_i32 s76, s76, 10240
  s_and_b32 s67, s66, 3
  s_lshl_b32 s67, s67, 11
  s_add_u32 s76, s76, s67
  v_mul_f32 v9, v5, v5
  s_lshl_b32 s67, s54, 8
  v_lshlrev_b32 v8, 4, v7
  v_add_u32 v8, s67, v8
  v_and_b32 v6, 31, v0
  s_and_b32 s67, s53, 1
  s_lshl_b32 s67, s67, 5
  v_add_u32 v6, s67, v6
  v_lshlrev_b32 v6, 4, v6
  v_lshl_add_u32 v6, v7, 10, v6
  s_lshl_b32 s67, s55, 1
  s_lshr_b32 s68, s53, 1
  s_add_u32 s67, s67, s68
  s_mul_i32 s67, s67, 399360
  s_add_u32 s67, s67, 7864320
  v_add_u32 v6, s67, v6
  ds_read_b128 v[12:15], v8 offset:512
  s_waitcnt lgkmcnt(0)
  v_fma_f32 v64, -v4, v12, v64
  v_fma_f32 v65, -v4, v13, v65
  v_fma_f32 v66, -v4, v14, v66
  v_fma_f32 v67, -v4, v15, v67
  ds_read_b128 v[12:15], v8 offset:544
  s_waitcnt lgkmcnt(0)
  v_fma_f32 v68, -v4, v12, v68
  v_fma_f32 v69, -v4, v13, v69
  v_fma_f32 v70, -v4, v14, v70
  v_fma_f32 v71, -v4, v15, v71
  ds_read_b128 v[12:15], v8 offset:576
  s_waitcnt lgkmcnt(0)
  v_fma_f32 v72, -v4, v12, v72
  v_fma_f32 v73, -v4, v13, v73
  v_fma_f32 v74, -v4, v14, v74
  v_fma_f32 v75, -v4, v15, v75
  ds_read_b128 v[12:15], v8 offset:608
  s_waitcnt lgkmcnt(0)
  v_fma_f32 v76, -v4, v12, v76
  v_fma_f32 v77, -v4, v13, v77
  v_fma_f32 v78, -v4, v14, v78
  v_fma_f32 v79, -v4, v15, v79
  v_mul_f32 v64, v64, v72
  v_mul_f32 v65, v65, v73
  v_mul_f32 v66, v66, v74
  v_mul_f32 v67, v67, v75
  v_mul_f32 v68, v68, v76
  v_mul_f32 v69, v69, v77
  v_mul_f32 v70, v70, v78
  v_mul_f32 v71, v71, v79
  v_mul_f32 v64, v9, v64
  v_mul_f32 v65, v9, v65
  v_mul_f32 v66, v9, v66
  v_mul_f32 v67, v9, v67
  v_mul_f32 v68, v9, v68
  v_mul_f32 v69, v9, v69
  v_mul_f32 v70, v9, v70
  v_mul_f32 v71, v9, v71
  v_cvt_pk_bf16_f32 v72, v64, v65
  v_cvt_pk_bf16_f32 v73, v66, v67
  v_cvt_pk_bf16_f32 v74, v68, v69
  v_cvt_pk_bf16_f32 v75, v70, v71
  s_nop 0
  v_permlane32_swap_b32 v72, v74
  v_permlane32_swap_b32 v73, v75
  buffer_store_dwordx4 v[72:75], v6, s[48:51], s76 offen sc1
  s_mov_b32 s50, 24100864
  s_add_u32 s66, s58, 0
  s_lshl_b32 s66, s66, 2
  s_lshl_b32 s67, s54, 1
  s_add_u32 s66, s66, s67
  s_add_u32 s66, s66, 1
  s_lshr_b32 s76, s66, 2
  s_mul_i32 s76, s76, 10240
  s_and_b32 s67, s66, 3
  s_lshl_b32 s67, s67, 11
  s_add_u32 s76, s76, s67
  v_mul_f32 v9, v5, v5
  s_lshl_b32 s67, s54, 8
  v_lshlrev_b32 v8, 4, v7
  v_add_u32 v8, s67, v8
  ds_read_b128 v[12:15], v8 offset:640
  s_waitcnt lgkmcnt(0)
  v_fma_f32 v80, -v4, v12, v80
  v_fma_f32 v81, -v4, v13, v81
  v_fma_f32 v82, -v4, v14, v82
  v_fma_f32 v83, -v4, v15, v83
  ds_read_b128 v[12:15], v8 offset:672
  s_waitcnt lgkmcnt(0)
  v_fma_f32 v84, -v4, v12, v84
  v_fma_f32 v85, -v4, v13, v85
  v_fma_f32 v86, -v4, v14, v86
  v_fma_f32 v87, -v4, v15, v87
  ds_read_b128 v[12:15], v8 offset:704
  s_waitcnt lgkmcnt(0)
  v_fma_f32 v88, -v4, v12, v88
  v_fma_f32 v89, -v4, v13, v89
  v_fma_f32 v90, -v4, v14, v90
  v_fma_f32 v91, -v4, v15, v91
  ds_read_b128 v[12:15], v8 offset:736
  s_waitcnt lgkmcnt(0)
  v_fma_f32 v92, -v4, v12, v92
  v_fma_f32 v93, -v4, v13, v93
  v_fma_f32 v94, -v4, v14, v94
  v_fma_f32 v95, -v4, v15, v95
  v_mul_f32 v80, v80, v88
  v_mul_f32 v81, v81, v89
  v_mul_f32 v82, v82, v90
  v_mul_f32 v83, v83, v91
  v_mul_f32 v84, v84, v92
  v_mul_f32 v85, v85, v93
  v_mul_f32 v86, v86, v94
  v_mul_f32 v87, v87, v95
  v_mul_f32 v80, v9, v80
  v_mul_f32 v81, v9, v81
  v_mul_f32 v82, v9, v82
  v_mul_f32 v83, v9, v83
  v_mul_f32 v84, v9, v84
  v_mul_f32 v85, v9, v85
  v_mul_f32 v86, v9, v86
  v_mul_f32 v87, v9, v87
  v_cvt_pk_bf16_f32 v88, v80, v81
  v_cvt_pk_bf16_f32 v89, v82, v83
  v_cvt_pk_bf16_f32 v90, v84, v85
  v_cvt_pk_bf16_f32 v91, v86, v87
  s_nop 0
  v_permlane32_swap_b32 v88, v90
  v_permlane32_swap_b32 v89, v91
  buffer_store_dwordx4 v[88:91], v6, s[48:51], s76 offen sc1
  s_mul_i32 s77, s55, 5
  s_add_u32 s77, s77, s56
  s_sub_u32 s77, s77, 10
  s_lshl_b32 s77, s77, 3
  s_add_u32 s77, s77, s52
  s_mov_b32 s80, s16
  s_and_b32 s81, s17, 0xffff
  s_mov_b32 s82, 2211840
  s_mov_b32 s83, 0x20000
  s_mov_b32 s84, s8
  s_and_b32 s85, s9, 0xffff
  s_mov_b32 s86, 819200
  s_mov_b32 s87, 0x20000
  v_lshlrev_b32 v100, 4, v0
  s_mov_b32 s48, s22
  s_and_b32 s49, s23, 0xffff
  s_mov_b32 s50, 24100864
  s_mov_b32 s51, 0x20000
  s_waitcnt vmcnt(2)
  s_add_u32 s64, s77, 0
  s_min_u32 s64, s64, 3119
  s_mul_i32 s65, s64, 52429
  s_lshr_b32 s65, s65, 18
  s_mul_i32 s66, s65, 5
  s_sub_u32 s66, s64, s66
  s_mul_i32 s69, s65, 5120
  s_lshl_b32 s76, s66, 10
  s_add_u32 s69, s69, s76
  s_add_u32 s69, s69, 20643840
  buffer_store_dwordx4 v[104:107], v100, s[40:43], s69 offen sc1
  s_add_u32 s64, s77, 640
  s_min_u32 s64, s64, 3119
  s_mul_i32 s65, s64, 52429
  s_lshr_b32 s65, s65, 18
  s_mul_i32 s66, s65, 5
  s_sub_u32 s66, s64, s66
  s_mul_i32 s69, s65, 5120
  s_lshl_b32 s76, s66, 10
  s_add_u32 s69, s69, s76
  s_add_u32 s69, s69, 20643840
  buffer_store_dwordx4 v[108:111], v100, s[40:43], s69 offen sc1
  s_add_u32 s64, s77, 1280
  s_min_u32 s64, s64, 3119
  s_mul_i32 s65, s64, 52429
  s_lshr_b32 s65, s65, 18
  s_mul_i32 s66, s65, 5
  s_sub_u32 s66, s64, s66
  s_mul_i32 s69, s65, 5120
  s_lshl_b32 s76, s66, 10
  s_add_u32 s69, s69, s76
  s_add_u32 s69, s69, 20643840
  buffer_store_dwordx4 v[112:115], v100, s[40:43], s69 offen sc1
  s_add_u32 s64, s77, 1920
  s_min_u32 s64, s64, 3119
  s_mul_i32 s65, s64, 52429
  s_lshr_b32 s65, s65, 18
  s_mul_i32 s66, s65, 5
  s_sub_u32 s66, s64, s66
  s_mul_i32 s69, s65, 5120
  s_lshl_b32 s76, s66, 10
  s_add_u32 s69, s69, s76
  s_add_u32 s69, s69, 20643840
  buffer_store_dwordx4 v[116:119], v100, s[40:43], s69 offen sc1
  s_add_u32 s64, s77, 2560
  s_min_u32 s64, s64, 3119
  s_mul_i32 s65, s64, 52429
  s_lshr_b32 s65, s65, 18
  s_mul_i32 s66, s65, 5
  s_sub_u32 s66, s64, s66
  s_mul_i32 s69, s65, 5120
  s_lshl_b32 s76, s66, 10
  s_add_u32 s69, s69, s76
  s_add_u32 s69, s69, 20643840
  buffer_store_dwordx4 v[120:123], v100, s[40:43], s69 offen sc1
  s_cmp_eq_u32 s52, 0
  s_cbranch_scc0 L_kvf_ok2
  s_lshr_b32 s84, s60, 5
  s_and_b32 s85, s60, 31
  v_mbcnt_lo_u32_b32 v64, -1, 0
  v_mbcnt_hi_u32_b32 v64, -1, v64
  s_lshl_b32 s64, s84, 5
  s_sub_i32 s64, s64, 32
  v_add_u32 v64, s64, v64
  v_cmp_le_i32 vcc, 0, v64
  v_mov_b32 v65, 0
  s_nop 0
  v_cndmask_b32 v65, v65, 1, vcc
  v_max_i32 v64, 0, v64
  v_lshlrev_b32 v64, 7, v64
  v_add_u32 v64, 24068096, v64
  s_mov_b32 s79, 0
L_wf2:
  buffer_load_dword v66, v64, s[40:43], 0 offen sc1
  s_waitcnt vmcnt(0)
L_wfc2:
  v_cmp_lt_u32 vcc, v66, v65
  s_nop 0
  s_cbranch_vccz L_wfok2
L_wfs2:
  s_sleep 8
  s_add_u32 s79, s79, 1
  s_cmp_lt_u32 s79, 0x40000
  s_cbranch_scc1 L_wf2
L_wfok2:
L_kvf_ok2:
  s_lshr_b32 s84, s60, 5
  s_and_b32 s85, s60, 31
  s_barrier
  v_mbcnt_lo_u32_b32 v11, -1, 0
  v_mbcnt_hi_u32_b32 v11, -1, v11
  v_lshlrev_b32 v11, 4, v11
  s_lshl_b32 s76, s84, 11
  s_mul_i32 s86, s85, 81920
  s_add_u32 s87, s86, s76
  s_add_u32 s86, s87, 0x27f800
  s_add_u32 s64, s52, 0
  s_lshr_b32 s65, s64, 2
  s_and_b32 s66, s64, 3
  s_lshl_b32 s66, s66, 10
  s_mul_i32 s67, s65, 16384
  s_add_u32 s67, s67, s66
  s_add_u32 s67, s67, s86
  s_mul_i32 s65, s65, 4128
  s_add_u32 s65, s65, s66
  s_add_u32 m0, s65, 108032
  s_nop 0
  buffer_load_dwordx4 v11, s[40:43], s67 offen sc1 lds
  s_add_u32 s64, s52, 8
  s_lshr_b32 s65, s64, 2
  s_and_b32 s66, s64, 3
  s_lshl_b32 s66, s66, 10
  s_mul_i32 s67, s65, 16384
  s_add_u32 s67, s67, s66
  s_add_u32 s67, s67, s86
  s_mul_i32 s65, s65, 4128
  s_add_u32 s65, s65, s66
  s_add_u32 m0, s65, 108032
  s_nop 0
  buffer_load_dwordx4 v11, s[40:43], s67 offen sc1 lds
  s_add_u32 s64, s52, 16
  s_cmp_ge_u32 s64, 20
  s_cselect_b32 s65, 20, 0
  s_cselect_b32 s68, 2621440, 0
  s_cselect_b32 s69, 20640, 0
  s_sub_u32 s64, s64, s65
  s_lshr_b32 s65, s64, 2
  s_and_b32 s66, s64, 3
  s_lshl_b32 s66, s66, 10
  s_mul_i32 s67, s65, 16384
  s_add_u32 s67, s67, s66
  s_add_u32 s67, s67, s86
  s_mul_i32 s65, s65, 4128
  s_add_u32 s65, s65, s66
  s_add_u32 s67, s67, s68
  s_add_u32 s65, s65, s69
  s_add_u32 m0, s65, 108032
  s_nop 0
  buffer_load_dwordx4 v11, s[40:43], s67 offen sc1 lds
  s_add_u32 s64, s52, 24
  s_sub_u32 s64, s64, 20
  s_lshr_b32 s65, s64, 2
  s_and_b32 s66, s64, 3
  s_lshl_b32 s66, s66, 10
  s_mul_i32 s67, s65, 16384
  s_add_u32 s67, s67, s66
  s_add_u32 s67, s67, s86
  s_mul_i32 s65, s65, 4128
  s_add_u32 s65, s65, s66
  s_add_u32 s67, s67, 2621440
  s_add_u32 m0, s65, 128672
  s_nop 0
  buffer_load_dwordx4 v11, s[40:43], s67 offen sc1 lds
  s_add_u32 s64, s52, 32
  s_sub_u32 s64, s64, 20
  s_lshr_b32 s65, s64, 2
  s_and_b32 s66, s64, 3
  s_lshl_b32 s66, s66, 10
  s_mul_i32 s67, s65, 16384
  s_add_u32 s67, s67, s66
  s_add_u32 s67, s67, s86
  s_mul_i32 s65, s65, 4128
  s_add_u32 s65, s65, s66
  s_add_u32 s67, s67, 2621440
  s_add_u32 m0, s65, 128672
  s_nop 0
  buffer_load_dwordx4 v11, s[40:43], s67 offen sc1 lds
  s_add_u32 s64, s52, 40
  s_sub_u32 s64, s64, 40
  s_min_u32 s64, s64, 9
  s_lshr_b32 s65, s64, 1
  s_and_b32 s66, s64, 1
  s_lshl_b32 s66, s66, 10
  s_mul_i32 s67, s65, 16384
  s_add_u32 s67, s67, s66
  s_add_u32 s67, s67, s87
  s_lshl_b32 s65, s65, 11
  s_add_u32 s65, s65, s66
  s_add_u32 m0, s65, 149312
  s_nop 0
  buffer_load_dwordx4 v11, s[40:43], s67 offen sc1 lds
  s_add_u32 s64, s52, 48
  s_sub_u32 s64, s64, 40
  s_min_u32 s64, s64, 9
  s_lshr_b32 s65, s64, 1
  s_and_b32 s66, s64, 1
  s_lshl_b32 s66, s66, 10
  s_mul_i32 s67, s65, 16384
  s_add_u32 s67, s67, s66
  s_add_u32 s67, s67, s87
  s_lshl_b32 s65, s65, 11
  s_add_u32 s65, s65, s66
  s_add_u32 m0, s65, 149312
  s_nop 0
  buffer_load_dwordx4 v11, s[40:43], s67 offen sc1 lds
  s_waitcnt vmcnt(7)
  s_barrier
  s_cmp_eq_u32 s52, 0
  s_cbranch_scc0 L_pub3_3375
  v_mov_b32 v12, 3
  v_mov_b32 v13, 3
  v_mov_b32 v14, 3
  v_mov_b32 v15, 3
  v_mbcnt_lo_u32_b32 v10, -1, 0
  v_lshlrev_b32 v10, 4, v10
  s_lshl_b32 s64, s60, 7
  s_add_u32 s64, s64, 24068096
  s_mov_b64 s[72:73], exec
  s_mov_b64 exec, 0xff
  buffer_store_dwordx4 v[12:15], v10, s[40:43], s64 offen sc1
  s_mov_b64 exec, s[72:73]
L_pub3_3375:
  s_waitcnt vmcnt(0)
L_p1_done:
  v_mbcnt_lo_u32_b32 v0, -1, 0
  v_mbcnt_hi_u32_b32 v0, -1, v0
  v_mbcnt_lo_u32_b32 v234, -1, 0
  v_mbcnt_hi_u32_b32 v234, -1, v234
  v_subrev_u32 v59, 16, v234
  v_mul_u32_u24 v235, 52429, v59
  v_lshrrev_b32 v235, 18, v235
  v_mad_u32_u24 v235, v235, 11, v59
  v_add_u32 v235, 10, v235
  s_lshr_b32 s64, s61, 1
  s_lshl_b32 s64, s64, 4
  v_add_u32 v59, s64, v234
  v_cmp_gt_u32 vcc, 16, v234
  s_nop 1
  v_cndmask_b32 v235, v235, v59, vcc
  v_lshlrev_b32 v234, 7, v235
  v_mov_b32 v235, 3
  v_cndmask_b32 v235, v235, 2, vcc
  v_add_u32 v234, 24068096, v234
  v_mbcnt_lo_u32_b32 v236, -1, 0
  v_mbcnt_hi_u32_b32 v236, -1, v236
  v_add_u32 v236, 64, v236
  v_subrev_u32 v59, 16, v236
  v_mul_u32_u24 v237, 52429, v59
  v_lshrrev_b32 v237, 18, v237
  v_mad_u32_u24 v237, v237, 11, v59
  v_add_u32 v237, 10, v237
  v_cmp_gt_u32 vcc, 96, v236
  v_min_u32 v237, 255, v237
  v_lshlrev_b32 v236, 7, v237
  v_mov_b32 v237, 0
  v_cndmask_b32 v237, v237, 3, vcc
  v_add_u32 v236, 24068096, v236
  v_and_b32 v2, 31, v0
  v_lshrrev_b32 v3, 5, v0
  s_lshl_b32 s64, s52, 8
  s_add_u32 s65, s64, 108032
  v_lshlrev_b32 v7, 3, v2
  v_add_u32 v7, s65, v7
  v_lshl_add_u32 v14, v3, 12, v7
  v_mul_u32_u24 v4, 8256, v3
  v_add_u32 v4, v4, v7
  v_mov_b32 v5, v7
  v_mov_b32 v16, 0x3f80
  v_mov_b32 v17, 0
  s_lshl_b32 s65, s52, 9
  s_add_u32 s65, s65, 159616
  v_lshlrev_b32 v18, 3, v0
  v_add_u32 v18, s65, v18
  ds_write_b64 v18, v[16:17]
  v_mov_b32 v18, 163712
  v_mov_b32 v16, 0
  v_lshl_add_u32 v18, v0, 2, v18
  s_mov_b64 exec, 0xf
  ds_write_b32 v18, v16
  s_mov_b64 exec, -1
  v_lshrrev_b32 v16, 4, v0
  v_and_b32 v17, 1, v16
  v_lshrrev_b32 v16, 1, v16
  v_bfe_u32 v18, v0, 2, 2
  v_and_b32 v19, 3, v0
  v_lshl_add_u32 v18, v16, 2, v18
  v_lshlrev_b32 v18, 3, v18
  s_add_u32 s65, s64, 108032
  v_add_u32 v18, s65, v18
  v_mul_u32_u24 v20, 4128, v19
  v_add_u32 v20, 20640, v20
  v_mov_b32 v21, 37152
  v_mov_b32 v22, 51584
  v_cmp_eq_u32 vcc, 0, v19
  s_nop 1
  v_cndmask_b32 v21, v22, v21, vcc
  v_cmp_eq_u32 vcc, 1, v17
  s_nop 1
  v_cndmask_b32 v20, v20, v21, vcc
  v_add_u32 v6, v20, v18
  v_lshlrev_b32 v16, 2, v3
  v_sub_u32 v16, v2, v16
  s_mul_i32 s86, s61, 399360
  s_add_u32 s86, s86, 7864320
  s_add_u32 s86, s86, s70
  s_mul_i32 s87, s62, 399360
  s_add_u32 s87, s87, 20643840
  s_add_u32 s87, s87, s70
  v_mbcnt_lo_u32_b32 v241, -1, 0
  v_mbcnt_hi_u32_b32 v241, -1, v241
  v_lshlrev_b32 v241, 4, v241
  v_mbcnt_lo_u32_b32 v242, -1, 0
  v_mbcnt_hi_u32_b32 v242, -1, v242
  s_and_b32 s64, s62, 3
  s_lshl_b32 s64, s64, 4
  v_add_u32 v243, s64, v242
  v_lshlrev_b32 v243, 7, v243
  s_sub_u32 s64, s86, s70
  v_add_u32 v243, s64, v243
  s_and_b32 s64, s61, 7
  s_mul_i32 s64, s64, 10
  s_sub_u32 s64, s64, 16
  v_add_u32 v244, s64, v242
  v_lshlrev_b32 v244, 7, v244
  s_sub_u32 s64, s87, s70
  v_add_u32 v244, s64, v244
  v_cmp_gt_u32 vcc, 16, v242
  s_nop 1
  v_cndmask_b32 v242, v244, v243, vcc
  s_and_b32 s64, s61, 7
  s_mul_i32 s64, s64, 1
  s_and_b32 s65, s62, 3
  s_mul_i32 s65, s65, 1
  s_add_u32 s88, s64, s65
  s_min_u32 s89, s88, 10
  s_waitcnt lgkmcnt(0)
  s_barrier
  ds_read_b64 v[8:9], v14 offset:41280
  ds_read_b64 v[10:11], v14 offset:43328
  ds_read_b64 v[12:13], v7 offset:49472
  s_sub_u32 s76, 8, s52
  s_cmp_eq_u32 s84, 0
  s_cselect_b32 s76, s76, 0
  ds_read_b64 v[24:25], v4 offset:0
  ds_read_b64 v[26:27], v4 offset:4128
  ds_read_b64 v[28:29], v5 offset:16512
  ds_read_b64 v[30:31], v4 offset:256
  ds_read_b64 v[32:33], v4 offset:4384
  ds_read_b64 v[34:35], v5 offset:16768
  s_waitcnt lgkmcnt(6)
  v_cmp_eq_u32 vcc, 1, v3
  v_mov_b32 v17, 0
  s_nop 0
  v_cndmask_b32 v12, v12, v17, vcc
  v_cndmask_b32 v13, v13, v17, vcc
  ds_read_b64 v[36:37], v4 offset:512
  ds_read_b64 v[38:39], v4 offset:4640
  ds_read_b64 v[40:41], v5 offset:17024
  s_waitcnt lgkmcnt(6)
  v_mfma_f32_32x32x16_bf16 v[64:79], v[24:27], v[8:11], 0
  v_mfma_f32_32x32x8_bf16 v[64:79], v[28:29], v[12:13], v[64:79]
  ds_read_b64 v[24:25], v4 offset:768
  ds_read_b64 v[26:27], v4 offset:4896
  ds_read_b64 v[28:29], v5 offset:17280
  s_waitcnt lgkmcnt(6)
  v_mfma_f32_32x32x16_bf16 v[80:95], v[30:33], v[8:11], 0
  v_mfma_f32_32x32x8_bf16 v[80:95], v[34:35], v[12:13], v[80:95]
  ds_read_b64 v[30:31], v4 offset:1024
  ds_read_b64 v[32:33], v4 offset:5152
  ds_read_b64 v[34:35], v5 offset:17536
  s_waitcnt lgkmcnt(6)
  v_mfma_f32_32x32x16_bf16 v[96:111], v[36:39], v[8:11], 0
  v_mfma_f32_32x32x8_bf16 v[96:111], v[40:41], v[12:13], v[96:111]
  ds_read_b64 v[36:37], v4 offset:1280
  ds_read_b64 v[38:39], v4 offset:5408
  ds_read_b64 v[40:41], v5 offset:17792
  s_waitcnt lgkmcnt(6)
  v_mfma_f32_32x32x16_bf16 v[112:127], v[24:27], v[8:11], 0
  v_mfma_f32_32x32x8_bf16 v[112:127], v[28:29], v[12:13], v[112:127]
  ds_read_b64 v[24:25], v4 offset:1536
  ds_read_b64 v[26:27], v4 offset:5664
  ds_read_b64 v[28:29], v5 offset:18048
  s_waitcnt lgkmcnt(6)
  v_mfma_f32_32x32x16_bf16 v[128:143], v[30:33], v[8:11], 0
  v_mfma_f32_32x32x8_bf16 v[128:143], v[34:35], v[12:13], v[128:143]
  ds_read_b64 v[30:31], v4 offset:1792
  ds_read_b64 v[32:33], v4 offset:5920
  ds_read_b64 v[34:35], v5 offset:18304
  s_waitcnt lgkmcnt(6)
  v_mfma_f32_32x32x16_bf16 v[144:159], v[36:39], v[8:11], 0
  v_mfma_f32_32x32x8_bf16 v[144:159], v[40:41], v[12:13], v[144:159]
  ds_read_b64 v[36:37], v4 offset:2048
  ds_read_b64 v[38:39], v4 offset:6176
  ds_read_b64 v[40:41], v5 offset:18560
  s_waitcnt lgkmcnt(6)
  v_mfma_f32_32x32x16_bf16 v[160:175], v[24:27], v[8:11], 0
  v_mfma_f32_32x32x8_bf16 v[160:175], v[28:29], v[12:13], v[160:175]
  s_waitcnt lgkmcnt(3)
  v_mfma_f32_32x32x16_bf16 v[176:191], v[30:33], v[8:11], 0
  v_mfma_f32_32x32x8_bf16 v[176:191], v[34:35], v[12:13], v[176:191]
  s_waitcnt lgkmcnt(0)
  v_mfma_f32_32x32x16_bf16 v[192:207], v[36:39], v[8:11], 0
  v_mfma_f32_32x32x8_bf16 v[192:207], v[40:41], v[12:13], v[192:207]
  v_mov_b32 v17, 0xff800000
  v_cmp_ge_i32 vcc, v16, 0
  s_nop 9
  v_cndmask_b32 v192, v17, v192, vcc
  v_cndmask_b32 v64, v64, v17, vcc
  v_cmp_ge_i32 vcc, v16, 1
  s_nop 1
  v_cndmask_b32 v193, v17, v193, vcc
  v_cndmask_b32 v65, v65, v17, vcc
  v_cmp_ge_i32 vcc, v16, 2
  s_nop 1
  v_cndmask_b32 v194, v17, v194, vcc
  v_cndmask_b32 v66, v66, v17, vcc
  v_cmp_ge_i32 vcc, v16, 3
  s_nop 1
  v_cndmask_b32 v195, v17, v195, vcc
  v_cndmask_b32 v67, v67, v17, vcc
  v_cmp_ge_i32 vcc, v16, 8
  s_nop 1
  v_cndmask_b32 v196, v17, v196, vcc
  v_cndmask_b32 v68, v68, v17, vcc
  v_cmp_ge_i32 vcc, v16, 9
  s_nop 1
  v_cndmask_b32 v197, v17, v197, vcc
  v_cndmask_b32 v69, v69, v17, vcc
  v_cmp_ge_i32 vcc, v16, 10
  s_nop 1
  v_cndmask_b32 v198, v17, v198, vcc
  v_cndmask_b32 v70, v70, v17, vcc
  v_cmp_ge_i32 vcc, v16, 11
  s_nop 1
  v_cndmask_b32 v199, v17, v199, vcc
  v_cndmask_b32 v71, v71, v17, vcc
  v_cmp_ge_i32 vcc, v16, 16
  s_nop 1
  v_cndmask_b32 v200, v17, v200, vcc
  v_cndmask_b32 v72, v72, v17, vcc
  v_cmp_ge_i32 vcc, v16, 17
  s_nop 1
  v_cndmask_b32 v201, v17, v201, vcc
  v_cndmask_b32 v73, v73, v17, vcc
  v_cmp_ge_i32 vcc, v16, 18
  s_nop 1
  v_cndmask_b32 v202, v17, v202, vcc
  v_cndmask_b32 v74, v74, v17, vcc
  v_cmp_ge_i32 vcc, v16, 19
  s_nop 1
  v_cndmask_b32 v203, v17, v203, vcc
  v_cndmask_b32 v75, v75, v17, vcc
  v_cmp_ge_i32 vcc, v16, 24
  s_nop 1
  v_cndmask_b32 v204, v17, v204, vcc
  v_cndmask_b32 v76, v76, v17, vcc
  v_cmp_ge_i32 vcc, v16, 25
  s_nop 1
  v_cndmask_b32 v205, v17, v205, vcc
  v_cndmask_b32 v77, v77, v17, vcc
  v_cmp_ge_i32 vcc, v16, 26
  s_nop 1
  v_cndmask_b32 v206, v17, v206, vcc
  v_cndmask_b32 v78, v78, v17, vcc
  v_cmp_ge_i32 vcc, v16, 27
  s_nop 1
  v_cndmask_b32 v207, v17, v207, vcc
  v_cndmask_b32 v79, v79, v17, vcc
  s_cmp_gt_u32 s76, 0
  s_cbranch_scc0 L_a_nbdone
  v_mov_b32 v64, v17
  v_mov_b32 v65, v17
  v_mov_b32 v66, v17
  v_mov_b32 v67, v17
  v_mov_b32 v68, v17
  v_mov_b32 v69, v17
  v_mov_b32 v70, v17
  v_mov_b32 v71, v17
  v_mov_b32 v72, v17
  v_mov_b32 v73, v17
  v_mov_b32 v74, v17
  v_mov_b32 v75, v17
  v_mov_b32 v76, v17
  v_mov_b32 v77, v17
  v_mov_b32 v78, v17
  v_mov_b32 v79, v17
  s_cmp_gt_u32 s76, 1
  s_cbranch_scc0 L_a_nbdone
  v_mov_b32 v80, v17
  v_mov_b32 v81, v17
  v_mov_b32 v82, v17
  v_mov_b32 v83, v17
  v_mov_b32 v84, v17
  v_mov_b32 v85, v17
  v_mov_b32 v86, v17
  v_mov_b32 v87, v17
  v_mov_b32 v88, v17
  v_mov_b32 v89, v17
  v_mov_b32 v90, v17
  v_mov_b32 v91, v17
  v_mov_b32 v92, v17
  v_mov_b32 v93, v17
  v_mov_b32 v94, v17
  v_mov_b32 v95, v17
  s_cmp_gt_u32 s76, 2
  s_cbranch_scc0 L_a_nbdone
  v_mov_b32 v96, v17
  v_mov_b32 v97, v17
  v_mov_b32 v98, v17
  v_mov_b32 v99, v17
  v_mov_b32 v100, v17
  v_mov_b32 v101, v17
  v_mov_b32 v102, v17
  v_mov_b32 v103, v17
  v_mov_b32 v104, v17
  v_mov_b32 v105, v17
  v_mov_b32 v106, v17
  v_mov_b32 v107, v17
  v_mov_b32 v108, v17
  v_mov_b32 v109, v17
  v_mov_b32 v110, v17
  v_mov_b32 v111, v17
  s_cmp_gt_u32 s76, 3
  s_cbranch_scc0 L_a_nbdone
  v_mov_b32 v112, v17
  v_mov_b32 v113, v17
  v_mov_b32 v114, v17
  v_mov_b32 v115, v17
  v_mov_b32 v116, v17
  v_mov_b32 v117, v17
  v_mov_b32 v118, v17
  v_mov_b32 v119, v17
  v_mov_b32 v120, v17
  v_mov_b32 v121, v17
  v_mov_b32 v122, v17
  v_mov_b32 v123, v17
  v_mov_b32 v124, v17
  v_mov_b32 v125, v17
  v_mov_b32 v126, v17
  v_mov_b32 v127, v17
  s_cmp_gt_u32 s76, 4
  s_cbranch_scc0 L_a_nbdone
  v_mov_b32 v128, v17
  v_mov_b32 v129, v17
  v_mov_b32 v130, v17
  v_mov_b32 v131, v17
  v_mov_b32 v132, v17
  v_mov_b32 v133, v17
  v_mov_b32 v134, v17
  v_mov_b32 v135, v17
  v_mov_b32 v136, v17
  v_mov_b32 v137, v17
  v_mov_b32 v138, v17
  v_mov_b32 v139, v17
  v_mov_b32 v140, v17
  v_mov_b32 v141, v17
  v_mov_b32 v142, v17
  v_mov_b32 v143, v17
  s_cmp_gt_u32 s76, 5
  s_cbranch_scc0 L_a_nbdone
  v_mov_b32 v144, v17
  v_mov_b32 v145, v17
  v_mov_b32 v146, v17
  v_mov_b32 v147, v17
  v_mov_b32 v148, v17
  v_mov_b32 v149, v17
  v_mov_b32 v150, v17
  v_mov_b32 v151, v17
  v_mov_b32 v152, v17
  v_mov_b32 v153, v17
  v_mov_b32 v154, v17
  v_mov_b32 v155, v17
  v_mov_b32 v156, v17
  v_mov_b32 v157, v17
  v_mov_b32 v158, v17
  v_mov_b32 v159, v17
  s_cmp_gt_u32 s76, 6
  s_cbranch_scc0 L_a_nbdone
  v_mov_b32 v160, v17
  v_mov_b32 v161, v17
  v_mov_b32 v162, v17
  v_mov_b32 v163, v17
  v_mov_b32 v164, v17
  v_mov_b32 v165, v17
  v_mov_b32 v166, v17
  v_mov_b32 v167, v17
  v_mov_b32 v168, v17
  v_mov_b32 v169, v17
  v_mov_b32 v170, v17
  v_mov_b32 v171, v17
  v_mov_b32 v172, v17
  v_mov_b32 v173, v17
  v_mov_b32 v174, v17
  v_mov_b32 v175, v17
  s_cmp_gt_u32 s76, 7
  s_cbranch_scc0 L_a_nbdone
  v_mov_b32 v176, v17
  v_mov_b32 v177, v17
  v_mov_b32 v178, v17
  v_mov_b32 v179, v17
  v_mov_b32 v180, v17
  v_mov_b32 v181, v17
  v_mov_b32 v182, v17
  v_mov_b32 v183, v17
  v_mov_b32 v184, v17
  v_mov_b32 v185, v17
  v_mov_b32 v186, v17
  v_mov_b32 v187, v17
  v_mov_b32 v188, v17
  v_mov_b32 v189, v17
  v_mov_b32 v190, v17
  v_mov_b32 v191, v17
L_a_nbdone:
  ds_read_b64_tr_b16 v[24:25], v6 offset:0
  ds_read_b64_tr_b16 v[26:27], v6 offset:64
  ds_read_b64_tr_b16 v[28:29], v6 offset:128
  ds_read_b64_tr_b16 v[30:31], v6 offset:192
  ds_read_b64_tr_b16 v[32:33], v6 offset:256
  ds_read_b64_tr_b16 v[34:35], v6 offset:320
  ds_read_b64_tr_b16 v[36:37], v6 offset:384
  ds_read_b64_tr_b16 v[38:39], v6 offset:448
  v_max3_f32 v48, v64, v65, v66
  v_max3_f32 v49, v67, v68, v69
  v_max3_f32 v48, v48, v70, v71
  v_max3_f32 v49, v49, v72, v73
  v_max3_f32 v48, v48, v74, v75
  v_max3_f32 v49, v49, v76, v77
  v_max3_f32 v48, v48, v78, v79
  v_max3_f32 v49, v49, v80, v81
  v_max3_f32 v48, v48, v82, v83
  v_max3_f32 v49, v49, v84, v85
  v_max3_f32 v48, v48, v86, v87
  v_max3_f32 v49, v49, v88, v89
  v_max3_f32 v48, v48, v90, v91
  v_max3_f32 v49, v49, v92, v93
  v_max3_f32 v48, v48, v94, v95
  v_max3_f32 v49, v49, v96, v97
  v_max3_f32 v48, v48, v98, v99
  v_max3_f32 v49, v49, v100, v101
  v_max3_f32 v48, v48, v102, v103
  v_max3_f32 v49, v49, v104, v105
  v_max3_f32 v48, v48, v106, v107
  v_max3_f32 v49, v49, v108, v109
  v_max3_f32 v48, v48, v110, v111
  v_max3_f32 v49, v49, v112, v113
  v_max3_f32 v48, v48, v114, v115
  v_max3_f32 v49, v49, v116, v117
  v_max3_f32 v48, v48, v118, v119
  v_max3_f32 v49, v49, v120, v121
  v_max3_f32 v48, v48, v122, v123
  v_max3_f32 v49, v49, v124, v125
  v_max3_f32 v48, v48, v126, v127
  v_max3_f32 v49, v49, v128, v129
  v_max3_f32 v48, v48, v130, v131
  v_max3_f32 v49, v49, v132, v133
  v_max3_f32 v48, v48, v134, v135
  v_max3_f32 v49, v49, v136, v137
  v_max3_f32 v48, v48, v138, v139
  v_max3_f32 v49, v49, v140, v141
  v_max3_f32 v48, v48, v142, v143
  v_max3_f32 v49, v49, v144, v145
  v_max3_f32 v48, v48, v146, v147
  v_max3_f32 v49, v49, v148, v149
  v_max3_f32 v48, v48, v150, v151
  v_max3_f32 v49, v49, v152, v153
  v_max3_f32 v48, v48, v154, v155
  v_max3_f32 v49, v49, v156, v157
  v_max3_f32 v48, v48, v158, v159
  v_max3_f32 v49, v49, v160, v161
  v_max3_f32 v48, v48, v162, v163
  v_max3_f32 v49, v49, v164, v165
  v_max3_f32 v48, v48, v166, v167
  v_max3_f32 v49, v49, v168, v169
  v_max3_f32 v48, v48, v170, v171
  v_max3_f32 v49, v49, v172, v173
  v_max3_f32 v48, v48, v174, v175
  v_max3_f32 v49, v49, v176, v177
  v_max3_f32 v48, v48, v178, v179
  v_max3_f32 v49, v49, v180, v181
  v_max3_f32 v48, v48, v182, v183
  v_max3_f32 v49, v49, v184, v185
  v_max3_f32 v48, v48, v186, v187
  v_max3_f32 v49, v49, v188, v189
  v_max3_f32 v48, v48, v190, v191
  v_max3_f32 v49, v49, v192, v193
  v_max3_f32 v48, v48, v194, v195
  v_max3_f32 v49, v49, v196, v197
  v_max3_f32 v48, v48, v198, v199
  v_max3_f32 v49, v49, v200, v201
  v_max3_f32 v48, v48, v202, v203
  v_max3_f32 v49, v49, v204, v205
  v_max3_f32 v48, v48, v206, v207
  v_max_f32 v48, v48, v49
  v_mov_b32 v49, v48
  s_nop 1
  v_permlane32_swap_b32 v48, v49
  v_max_f32 v48, v48, v49
  v_mov_b32 v49, v48
  v_pk_add_f32 v[64:65], v[64:65], v[48:49] neg_lo:[0,1] neg_hi:[0,1]
  v_pk_add_f32 v[66:67], v[66:67], v[48:49] neg_lo:[0,1] neg_hi:[0,1]
  v_pk_add_f32 v[68:69], v[68:69], v[48:49] neg_lo:[0,1] neg_hi:[0,1]
  v_pk_add_f32 v[70:71], v[70:71], v[48:49] neg_lo:[0,1] neg_hi:[0,1]
  v_pk_add_f32 v[72:73], v[72:73], v[48:49] neg_lo:[0,1] neg_hi:[0,1]
  v_pk_add_f32 v[74:75], v[74:75], v[48:49] neg_lo:[0,1] neg_hi:[0,1]
  v_pk_add_f32 v[76:77], v[76:77], v[48:49] neg_lo:[0,1] neg_hi:[0,1]
  v_pk_add_f32 v[78:79], v[78:79], v[48:49] neg_lo:[0,1] neg_hi:[0,1]
  v_exp_f32 v64, v64
  v_exp_f32 v65, v65
  v_exp_f32 v66, v66
  v_exp_f32 v67, v67
  v_exp_f32 v68, v68
  v_exp_f32 v69, v69
  v_exp_f32 v70, v70
  v_exp_f32 v71, v71
  v_exp_f32 v72, v72
  v_exp_f32 v73, v73
  v_exp_f32 v74, v74
  v_exp_f32 v75, v75
  v_exp_f32 v76, v76
  v_exp_f32 v77, v77
  v_exp_f32 v78, v78
  v_exp_f32 v79, v79
  v_cvt_pk_bf16_f32 v64, v64, v65
  v_cvt_pk_bf16_f32 v65, v66, v67
  v_cvt_pk_bf16_f32 v66, v68, v69
  v_cvt_pk_bf16_f32 v67, v70, v71
  v_cvt_pk_bf16_f32 v68, v72, v73
  v_cvt_pk_bf16_f32 v69, v74, v75
  v_cvt_pk_bf16_f32 v70, v76, v77
  v_cvt_pk_bf16_f32 v71, v78, v79
  buffer_load_dword v238, v234, s[40:43], 0 offen sc1
  buffer_load_dword v239, v236, s[40:43], 0 offen sc1
  ds_read_b64_tr_b16 v[40:41], v6 offset:512
  ds_read_b64_tr_b16 v[42:43], v6 offset:576
  ds_read_b64_tr_b16 v[44:45], v6 offset:640
  ds_read_b64_tr_b16 v[46:47], v6 offset:704
  s_waitcnt lgkmcnt(8)
  v_mfma_f32_32x32x16_bf16 v[208:223], v[24:27], v[64:67], 0
  v_mfma_f32_32x32x16_bf16 v[208:223], v[28:31], v[68:71], v[208:223]
  v_pk_add_f32 v[80:81], v[80:81], v[48:49] neg_lo:[0,1] neg_hi:[0,1]
  v_pk_add_f32 v[82:83], v[82:83], v[48:49] neg_lo:[0,1] neg_hi:[0,1]
  v_pk_add_f32 v[84:85], v[84:85], v[48:49] neg_lo:[0,1] neg_hi:[0,1]
  v_pk_add_f32 v[86:87], v[86:87], v[48:49] neg_lo:[0,1] neg_hi:[0,1]
  v_pk_add_f32 v[88:89], v[88:89], v[48:49] neg_lo:[0,1] neg_hi:[0,1]
  v_pk_add_f32 v[90:91], v[90:91], v[48:49] neg_lo:[0,1] neg_hi:[0,1]
  v_pk_add_f32 v[92:93], v[92:93], v[48:49] neg_lo:[0,1] neg_hi:[0,1]
  v_pk_add_f32 v[94:95], v[94:95], v[48:49] neg_lo:[0,1] neg_hi:[0,1]
  v_exp_f32 v80, v80
  v_exp_f32 v81, v81
  v_exp_f32 v82, v82
  v_exp_f32 v83, v83
  v_exp_f32 v84, v84
  v_exp_f32 v85, v85
  v_exp_f32 v86, v86
  v_exp_f32 v87, v87
  v_exp_f32 v88, v88
  v_exp_f32 v89, v89
  v_exp_f32 v90, v90
  v_exp_f32 v91, v91
  v_exp_f32 v92, v92
  v_exp_f32 v93, v93
  v_exp_f32 v94, v94
  v_exp_f32 v95, v95
  v_cvt_pk_bf16_f32 v80, v80, v81
  v_cvt_pk_bf16_f32 v81, v82, v83
  v_cvt_pk_bf16_f32 v82, v84, v85
  v_cvt_pk_bf16_f32 v83, v86, v87
  v_cvt_pk_bf16_f32 v84, v88, v89
  v_cvt_pk_bf16_f32 v85, v90, v91
  v_cvt_pk_bf16_f32 v86, v92, v93
  v_cvt_pk_bf16_f32 v87, v94, v95
  s_waitcnt vmcnt(0)
  s_cmp_eq_u32 s52, 0
  s_cbranch_scc0 L_a_nopoll
  s_mov_b32 s79, 0
  s_branch L_wfc3
L_wf3:
  buffer_load_dword v238, v234, s[40:43], 0 offen sc1
  buffer_load_dword v239, v236, s[40:43], 0 offen sc1
  s_waitcnt vmcnt(0)
L_wfc3:
  v_cmp_lt_u32 vcc, v238, v235
  s_nop 0
  s_cbranch_vccnz L_wfs3
  v_cmp_lt_u32 vcc, v239, v237
  s_nop 0
  s_cbranch_vccz L_wfok3
L_wfs3:
  s_sleep 8
  s_add_u32 s79, s79, 1
  s_cmp_lt_u32 s79, 0x40000
  s_cbranch_scc1 L_wf3
L_wfok3:
L_a_nopoll:
  s_barrier
  s_mov_b32 s66, 0
  s_add_u32 s64, s86, s66
  s_add_u32 m0, s70, 0
  s_nop 0
  buffer_load_dwordx4 v241, s[40:43], s64 offen sc1 lds
  s_cmp_lt_u32 s52, 2
  s_cbranch_scc0 L_g2d1
  s_mov_b32 s66, 0
  s_add_u32 s64, s87, s66
  s_add_u32 s64, s64, 8192
  s_add_u32 m0, s70, 16384
  s_nop 0
  buffer_load_dwordx4 v241, s[40:43], s64 offen sc1 lds
L_g2d1:
  s_mov_b32 s66, 0
  s_add_u32 s64, s87, s66
  s_add_u32 m0, s70, 8192
  s_nop 0
  buffer_load_dwordx4 v241, s[40:43], s64 offen sc1 lds
  ds_read_b64_tr_b16 v[24:25], v6 offset:768
  ds_read_b64_tr_b16 v[26:27], v6 offset:832
  ds_read_b64_tr_b16 v[28:29], v6 offset:896
  ds_read_b64_tr_b16 v[30:31], v6 offset:960
  s_waitcnt lgkmcnt(8)
  v_mfma_f32_32x32x16_bf16 v[208:223], v[32:35], v[80:83], v[208:223]
  v_mfma_f32_32x32x16_bf16 v[208:223], v[36:39], v[84:87], v[208:223]
  v_pk_add_f32 v[96:97], v[96:97], v[48:49] neg_lo:[0,1] neg_hi:[0,1]
  v_pk_add_f32 v[98:99], v[98:99], v[48:49] neg_lo:[0,1] neg_hi:[0,1]
  v_pk_add_f32 v[100:101], v[100:101], v[48:49] neg_lo:[0,1] neg_hi:[0,1]
  v_pk_add_f32 v[102:103], v[102:103], v[48:49] neg_lo:[0,1] neg_hi:[0,1]
  v_pk_add_f32 v[104:105], v[104:105], v[48:49] neg_lo:[0,1] neg_hi:[0,1]
  v_pk_add_f32 v[106:107], v[106:107], v[48:49] neg_lo:[0,1] neg_hi:[0,1]
  v_pk_add_f32 v[108:109], v[108:109], v[48:49] neg_lo:[0,1] neg_hi:[0,1]
  v_pk_add_f32 v[110:111], v[110:111], v[48:49] neg_lo:[0,1] neg_hi:[0,1]
  v_exp_f32 v96, v96
  v_exp_f32 v97, v97
  v_exp_f32 v98, v98
  v_exp_f32 v99, v99
  v_exp_f32 v100, v100
  v_exp_f32 v101, v101
  v_exp_f32 v102, v102
  v_exp_f32 v103, v103
  v_exp_f32 v104, v104
  v_exp_f32 v105, v105
  v_exp_f32 v106, v106
  v_exp_f32 v107, v107
  v_exp_f32 v108, v108
  v_exp_f32 v109, v109
  v_exp_f32 v110, v110
  v_exp_f32 v111, v111
  v_cvt_pk_bf16_f32 v96, v96, v97
  v_cvt_pk_bf16_f32 v97, v98, v99
  v_cvt_pk_bf16_f32 v98, v100, v101
  v_cvt_pk_bf16_f32 v99, v102, v103
  v_cvt_pk_bf16_f32 v100, v104, v105
  v_cvt_pk_bf16_f32 v101, v106, v107
  v_cvt_pk_bf16_f32 v102, v108, v109
  v_cvt_pk_bf16_f32 v103, v110, v111
  s_mov_b32 s66, 20480
  s_add_u32 s64, s86, s66
  s_add_u32 m0, s70, 18432
  s_nop 0
  buffer_load_dwordx4 v241, s[40:43], s64 offen sc1 lds
  s_cmp_lt_u32 s52, 2
  s_cbranch_scc0 L_g2d2
  s_mov_b32 s66, 20480
  s_add_u32 s64, s87, s66
  s_add_u32 s64, s64, 8192
  s_add_u32 m0, s70, 34816
  s_nop 0
  buffer_load_dwordx4 v241, s[40:43], s64 offen sc1 lds
L_g2d2:
  s_mov_b32 s66, 20480
  s_add_u32 s64, s87, s66
  s_add_u32 m0, s70, 26624
  s_nop 0
  buffer_load_dwordx4 v241, s[40:43], s64 offen sc1 lds
  ds_read_b64_tr_b16 v[32:33], v6 offset:1024
  ds_read_b64_tr_b16 v[34:35], v6 offset:1088
  ds_read_b64_tr_b16 v[36:37], v6 offset:1152
  ds_read_b64_tr_b16 v[38:39], v6 offset:1216
  s_waitcnt lgkmcnt(8)
  v_mfma_f32_32x32x16_bf16 v[208:223], v[40:43], v[96:99], v[208:223]
  v_mfma_f32_32x32x16_bf16 v[208:223], v[44:47], v[100:103], v[208:223]
  v_pk_add_f32 v[112:113], v[112:113], v[48:49] neg_lo:[0,1] neg_hi:[0,1]
  v_pk_add_f32 v[114:115], v[114:115], v[48:49] neg_lo:[0,1] neg_hi:[0,1]
  v_pk_add_f32 v[116:117], v[116:117], v[48:49] neg_lo:[0,1] neg_hi:[0,1]
  v_pk_add_f32 v[118:119], v[118:119], v[48:49] neg_lo:[0,1] neg_hi:[0,1]
  v_pk_add_f32 v[120:121], v[120:121], v[48:49] neg_lo:[0,1] neg_hi:[0,1]
  v_pk_add_f32 v[122:123], v[122:123], v[48:49] neg_lo:[0,1] neg_hi:[0,1]
  v_pk_add_f32 v[124:125], v[124:125], v[48:49] neg_lo:[0,1] neg_hi:[0,1]
  v_pk_add_f32 v[126:127], v[126:127], v[48:49] neg_lo:[0,1] neg_hi:[0,1]
  v_exp_f32 v112, v112
  v_exp_f32 v113, v113
  v_exp_f32 v114, v114
  v_exp_f32 v115, v115
  v_exp_f32 v116, v116
  v_exp_f32 v117, v117
  v_exp_f32 v118, v118
  v_exp_f32 v119, v119
  v_exp_f32 v120, v120
  v_exp_f32 v121, v121
  v_exp_f32 v122, v122
  v_exp_f32 v123, v123
  v_exp_f32 v124, v124
  v_exp_f32 v125, v125
  v_exp_f32 v126, v126
  v_exp_f32 v127, v127
  v_cvt_pk_bf16_f32 v112, v112, v113
  v_cvt_pk_bf16_f32 v113, v114, v115
  v_cvt_pk_bf16_f32 v114, v116, v117
  v_cvt_pk_bf16_f32 v115, v118, v119
  v_cvt_pk_bf16_f32 v116, v120, v121
  v_cvt_pk_bf16_f32 v117, v122, v123
  v_cvt_pk_bf16_f32 v118, v124, v125
  v_cvt_pk_bf16_f32 v119, v126, v127
  v_mov_b32 v59, 163712
  v_mov_b32 v60, 1
  s_mov_b64 exec, 1
  ds_add_rtn_u32 v61, v59, v60
  s_waitcnt lgkmcnt(0)
  s_mov_b64 exec, -1
  v_readfirstlane_b32 s64, v61
  s_nop 0
  s_cmp_eq_u32 s64, 7
  s_cbranch_scc0 L_arr4
  v_mov_b32 v52, 3
  v_mov_b32 v53, 3
  v_mov_b32 v54, 3
  v_mov_b32 v55, 3
  v_mbcnt_lo_u32_b32 v61, -1, 0
  v_lshlrev_b32 v61, 4, v61
  s_lshl_b32 s64, s60, 7
  s_add_u32 s64, s64, 24068096
  s_mov_b64 s[72:73], exec
  s_mov_b64 exec, 0xff
  buffer_store_dwordx4 v[52:55], v61, s[40:43], s64 offen sc1
  s_mov_b64 exec, s[72:73]
L_pub3_4059:
L_arr4:
  s_mov_b32 s66, 40960
  s_add_u32 s64, s86, s66
  s_add_u32 m0, s70, 36864
  s_nop 0
  buffer_load_dwordx4 v241, s[40:43], s64 offen sc1 lds
  s_cmp_lt_u32 s52, 2
  s_cbranch_scc0 L_g2d3
  s_mov_b32 s66, 40960
  s_add_u32 s64, s87, s66
  s_add_u32 s64, s64, 8192
  s_add_u32 m0, s70, 53248
  s_nop 0
  buffer_load_dwordx4 v241, s[40:43], s64 offen sc1 lds
L_g2d3:
  s_mov_b32 s66, 40960
  s_add_u32 s64, s87, s66
  s_add_u32 m0, s70, 45056
  s_nop 0
  buffer_load_dwordx4 v241, s[40:43], s64 offen sc1 lds
  ds_read_b64_tr_b16 v[40:41], v6 offset:1280
  ds_read_b64_tr_b16 v[42:43], v6 offset:1344
  ds_read_b64_tr_b16 v[44:45], v6 offset:1408
  ds_read_b64_tr_b16 v[46:47], v6 offset:1472
  s_waitcnt lgkmcnt(8)
  v_mfma_f32_32x32x16_bf16 v[208:223], v[24:27], v[112:115], v[208:223]
  v_mfma_f32_32x32x16_bf16 v[208:223], v[28:31], v[116:119], v[208:223]
  v_pk_add_f32 v[128:129], v[128:129], v[48:49] neg_lo:[0,1] neg_hi:[0,1]
  v_pk_add_f32 v[130:131], v[130:131], v[48:49] neg_lo:[0,1] neg_hi:[0,1]
  v_pk_add_f32 v[132:133], v[132:133], v[48:49] neg_lo:[0,1] neg_hi:[0,1]
  v_pk_add_f32 v[134:135], v[134:135], v[48:49] neg_lo:[0,1] neg_hi:[0,1]
  v_pk_add_f32 v[136:137], v[136:137], v[48:49] neg_lo:[0,1] neg_hi:[0,1]
  v_pk_add_f32 v[138:139], v[138:139], v[48:49] neg_lo:[0,1] neg_hi:[0,1]
  v_pk_add_f32 v[140:141], v[140:141], v[48:49] neg_lo:[0,1] neg_hi:[0,1]
  v_pk_add_f32 v[142:143], v[142:143], v[48:49] neg_lo:[0,1] neg_hi:[0,1]
  v_exp_f32 v128, v128
  v_exp_f32 v129, v129
  v_exp_f32 v130, v130
  v_exp_f32 v131, v131
  v_exp_f32 v132, v132
  v_exp_f32 v133, v133
  v_exp_f32 v134, v134
  v_exp_f32 v135, v135
  v_exp_f32 v136, v136
  v_exp_f32 v137, v137
  v_exp_f32 v138, v138
  v_exp_f32 v139, v139
  v_exp_f32 v140, v140
  v_exp_f32 v141, v141
  v_exp_f32 v142, v142
  v_exp_f32 v143, v143
  v_cvt_pk_bf16_f32 v128, v128, v129
  v_cvt_pk_bf16_f32 v129, v130, v131
  v_cvt_pk_bf16_f32 v130, v132, v133
  v_cvt_pk_bf16_f32 v131, v134, v135
  v_cvt_pk_bf16_f32 v132, v136, v137
  v_cvt_pk_bf16_f32 v133, v138, v139
  v_cvt_pk_bf16_f32 v134, v140, v141
  v_cvt_pk_bf16_f32 v135, v142, v143
  s_mov_b32 s66, 61440
  s_add_u32 s64, s86, s66
  s_add_u32 m0, s70, 55296
  s_nop 0
  buffer_load_dwordx4 v241, s[40:43], s64 offen sc1 lds
  s_cmp_lt_u32 s52, 2
  s_cbranch_scc0 L_g2d4
  s_mov_b32 s66, 61440
  s_add_u32 s64, s87, s66
  s_add_u32 s64, s64, 8192
  s_add_u32 m0, s70, 71680
  s_nop 0
  buffer_load_dwordx4 v241, s[40:43], s64 offen sc1 lds
L_g2d4:
  s_mov_b32 s66, 61440
  s_add_u32 s64, s87, s66
  s_add_u32 m0, s70, 63488
  s_nop 0
  buffer_load_dwordx4 v241, s[40:43], s64 offen sc1 lds
  ds_read_b64_tr_b16 v[24:25], v6 offset:1536
  ds_read_b64_tr_b16 v[26:27], v6 offset:1600
  ds_read_b64_tr_b16 v[28:29], v6 offset:1664
  ds_read_b64_tr_b16 v[30:31], v6 offset:1728
  s_waitcnt lgkmcnt(8)
  v_mfma_f32_32x32x16_bf16 v[208:223], v[32:35], v[128:131], v[208:223]
  v_mfma_f32_32x32x16_bf16 v[208:223], v[36:39], v[132:135], v[208:223]
  v_pk_add_f32 v[144:145], v[144:145], v[48:49] neg_lo:[0,1] neg_hi:[0,1]
  v_pk_add_f32 v[146:147], v[146:147], v[48:49] neg_lo:[0,1] neg_hi:[0,1]
  v_pk_add_f32 v[148:149], v[148:149], v[48:49] neg_lo:[0,1] neg_hi:[0,1]
  v_pk_add_f32 v[150:151], v[150:151], v[48:49] neg_lo:[0,1] neg_hi:[0,1]
  v_pk_add_f32 v[152:153], v[152:153], v[48:49] neg_lo:[0,1] neg_hi:[0,1]
  v_pk_add_f32 v[154:155], v[154:155], v[48:49] neg_lo:[0,1] neg_hi:[0,1]
  v_pk_add_f32 v[156:157], v[156:157], v[48:49] neg_lo:[0,1] neg_hi:[0,1]
  v_pk_add_f32 v[158:159], v[158:159], v[48:49] neg_lo:[0,1] neg_hi:[0,1]
  v_exp_f32 v144, v144
  v_exp_f32 v145, v145
  v_exp_f32 v146, v146
  v_exp_f32 v147, v147
  v_exp_f32 v148, v148
  v_exp_f32 v149, v149
  v_exp_f32 v150, v150
  v_exp_f32 v151, v151
  v_exp_f32 v152, v152
  v_exp_f32 v153, v153
  v_exp_f32 v154, v154
  v_exp_f32 v155, v155
  v_exp_f32 v156, v156
  v_exp_f32 v157, v157
  v_exp_f32 v158, v158
  v_exp_f32 v159, v159
  v_cvt_pk_bf16_f32 v144, v144, v145
  v_cvt_pk_bf16_f32 v145, v146, v147
  v_cvt_pk_bf16_f32 v146, v148, v149
  v_cvt_pk_bf16_f32 v147, v150, v151
  v_cvt_pk_bf16_f32 v148, v152, v153
  v_cvt_pk_bf16_f32 v149, v154, v155
  v_cvt_pk_bf16_f32 v150, v156, v157
  v_cvt_pk_bf16_f32 v151, v158, v159
  s_mov_b32 s66, 81920
  s_add_u32 s64, s86, s66
  s_add_u32 m0, s70, 73728
  s_nop 0
  buffer_load_dwordx4 v241, s[40:43], s64 offen sc1 lds
  s_cmp_lt_u32 s52, 2
  s_cbranch_scc0 L_g2d5
  s_mov_b32 s66, 81920
  s_add_u32 s64, s87, s66
  s_add_u32 s64, s64, 8192
  s_add_u32 m0, s70, 90112
  s_nop 0
  buffer_load_dwordx4 v241, s[40:43], s64 offen sc1 lds
L_g2d5:
  s_mov_b32 s66, 81920
  s_add_u32 s64, s87, s66
  s_add_u32 m0, s70, 81920
  s_nop 0
  buffer_load_dwordx4 v241, s[40:43], s64 offen sc1 lds
  ds_read_b64_tr_b16 v[32:33], v6 offset:1792
  ds_read_b64_tr_b16 v[34:35], v6 offset:1856
  ds_read_b64_tr_b16 v[36:37], v6 offset:1920
  ds_read_b64_tr_b16 v[38:39], v6 offset:1984
  s_waitcnt lgkmcnt(8)
  v_mfma_f32_32x32x16_bf16 v[208:223], v[40:43], v[144:147], v[208:223]
  v_mfma_f32_32x32x16_bf16 v[208:223], v[44:47], v[148:151], v[208:223]
  v_pk_add_f32 v[160:161], v[160:161], v[48:49] neg_lo:[0,1] neg_hi:[0,1]
  v_pk_add_f32 v[162:163], v[162:163], v[48:49] neg_lo:[0,1] neg_hi:[0,1]
  v_pk_add_f32 v[164:165], v[164:165], v[48:49] neg_lo:[0,1] neg_hi:[0,1]
  v_pk_add_f32 v[166:167], v[166:167], v[48:49] neg_lo:[0,1] neg_hi:[0,1]
  v_pk_add_f32 v[168:169], v[168:169], v[48:49] neg_lo:[0,1] neg_hi:[0,1]
  v_pk_add_f32 v[170:171], v[170:171], v[48:49] neg_lo:[0,1] neg_hi:[0,1]
  v_pk_add_f32 v[172:173], v[172:173], v[48:49] neg_lo:[0,1] neg_hi:[0,1]
  v_pk_add_f32 v[174:175], v[174:175], v[48:49] neg_lo:[0,1] neg_hi:[0,1]
  v_exp_f32 v160, v160
  v_exp_f32 v161, v161
  v_exp_f32 v162, v162
  v_exp_f32 v163, v163
  v_exp_f32 v164, v164
  v_exp_f32 v165, v165
  v_exp_f32 v166, v166
  v_exp_f32 v167, v167
  v_exp_f32 v168, v168
  v_exp_f32 v169, v169
  v_exp_f32 v170, v170
  v_exp_f32 v171, v171
  v_exp_f32 v172, v172
  v_exp_f32 v173, v173
  v_exp_f32 v174, v174
  v_exp_f32 v175, v175
  v_cvt_pk_bf16_f32 v160, v160, v161
  v_cvt_pk_bf16_f32 v161, v162, v163
  v_cvt_pk_bf16_f32 v162, v164, v165
  v_cvt_pk_bf16_f32 v163, v166, v167
  v_cvt_pk_bf16_f32 v164, v168, v169
  v_cvt_pk_bf16_f32 v165, v170, v171
  v_cvt_pk_bf16_f32 v166, v172, v173
  v_cvt_pk_bf16_f32 v167, v174, v175
  ds_read_b64_tr_b16 v[40:41], v6 offset:2048
  ds_read_b64_tr_b16 v[42:43], v6 offset:2112
  ds_read_b64_tr_b16 v[44:45], v6 offset:2176
  ds_read_b64_tr_b16 v[46:47], v6 offset:2240
  s_waitcnt lgkmcnt(8)
  v_mfma_f32_32x32x16_bf16 v[208:223], v[24:27], v[160:163], v[208:223]
  v_mfma_f32_32x32x16_bf16 v[208:223], v[28:31], v[164:167], v[208:223]
  v_pk_add_f32 v[176:177], v[176:177], v[48:49] neg_lo:[0,1] neg_hi:[0,1]
  v_pk_add_f32 v[178:179], v[178:179], v[48:49] neg_lo:[0,1] neg_hi:[0,1]
  v_pk_add_f32 v[180:181], v[180:181], v[48:49] neg_lo:[0,1] neg_hi:[0,1]
  v_pk_add_f32 v[182:183], v[182:183], v[48:49] neg_lo:[0,1] neg_hi:[0,1]
  v_pk_add_f32 v[184:185], v[184:185], v[48:49] neg_lo:[0,1] neg_hi:[0,1]
  v_pk_add_f32 v[186:187], v[186:187], v[48:49] neg_lo:[0,1] neg_hi:[0,1]
  v_pk_add_f32 v[188:189], v[188:189], v[48:49] neg_lo:[0,1] neg_hi:[0,1]
  v_pk_add_f32 v[190:191], v[190:191], v[48:49] neg_lo:[0,1] neg_hi:[0,1]
  v_exp_f32 v176, v176
  v_exp_f32 v177, v177
  v_exp_f32 v178, v178
  v_exp_f32 v179, v179
  v_exp_f32 v180, v180
  v_exp_f32 v181, v181
  v_exp_f32 v182, v182
  v_exp_f32 v183, v183
  v_exp_f32 v184, v184
  v_exp_f32 v185, v185
  v_exp_f32 v186, v186
  v_exp_f32 v187, v187
  v_exp_f32 v188, v188
  v_exp_f32 v189, v189
  v_exp_f32 v190, v190
  v_exp_f32 v191, v191
  v_cvt_pk_bf16_f32 v176, v176, v177
  v_cvt_pk_bf16_f32 v177, v178, v179
  v_cvt_pk_bf16_f32 v178, v180, v181
  v_cvt_pk_bf16_f32 v179, v182, v183
  v_cvt_pk_bf16_f32 v180, v184, v185
  v_cvt_pk_bf16_f32 v181, v186, v187
  v_cvt_pk_bf16_f32 v182, v188, v189
  v_cvt_pk_bf16_f32 v183, v190, v191
  s_waitcnt lgkmcnt(4)
  v_mfma_f32_32x32x16_bf16 v[208:223], v[32:35], v[176:179], v[208:223]
  v_mfma_f32_32x32x16_bf16 v[208:223], v[36:39], v[180:183], v[208:223]
  v_pk_add_f32 v[192:193], v[192:193], v[48:49] neg_lo:[0,1] neg_hi:[0,1]
  v_pk_add_f32 v[194:195], v[194:195], v[48:49] neg_lo:[0,1] neg_hi:[0,1]
  v_pk_add_f32 v[196:197], v[196:197], v[48:49] neg_lo:[0,1] neg_hi:[0,1]
  v_pk_add_f32 v[198:199], v[198:199], v[48:49] neg_lo:[0,1] neg_hi:[0,1]
  v_pk_add_f32 v[200:201], v[200:201], v[48:49] neg_lo:[0,1] neg_hi:[0,1]
  v_pk_add_f32 v[202:203], v[202:203], v[48:49] neg_lo:[0,1] neg_hi:[0,1]
  v_pk_add_f32 v[204:205], v[204:205], v[48:49] neg_lo:[0,1] neg_hi:[0,1]
  v_pk_add_f32 v[206:207], v[206:207], v[48:49] neg_lo:[0,1] neg_hi:[0,1]
  v_exp_f32 v192, v192
  v_exp_f32 v193, v193
  v_exp_f32 v194, v194
  v_exp_f32 v195, v195
  v_exp_f32 v196, v196
  v_exp_f32 v197, v197
  v_exp_f32 v198, v198
  v_exp_f32 v199, v199
  v_exp_f32 v200, v200
  v_exp_f32 v201, v201
  v_exp_f32 v202, v202
  v_exp_f32 v203, v203
  v_exp_f32 v204, v204
  v_exp_f32 v205, v205
  v_exp_f32 v206, v206
  v_exp_f32 v207, v207
  v_cvt_pk_bf16_f32 v192, v192, v193
  v_cvt_pk_bf16_f32 v193, v194, v195
  v_cvt_pk_bf16_f32 v194, v196, v197
  v_cvt_pk_bf16_f32 v195, v198, v199
  v_cvt_pk_bf16_f32 v196, v200, v201
  v_cvt_pk_bf16_f32 v197, v202, v203
  v_cvt_pk_bf16_f32 v198, v204, v205
  v_cvt_pk_bf16_f32 v199, v206, v207
  s_waitcnt lgkmcnt(0)
  v_mfma_f32_32x32x16_bf16 v[208:223], v[40:43], v[192:195], v[208:223]
  v_mfma_f32_32x32x16_bf16 v[208:223], v[44:47], v[196:199], v[208:223]
  s_nop 11
  v_mov_b32 v50, v216
  v_mov_b32 v51, v216
  s_nop 1
  v_permlane32_swap_b32 v50, v51
  v_rcp_f32 v51, v51
  s_nop 0
  v_mul_f32 v208, v208, v51
  v_mul_f32 v209, v209, v51
  v_mul_f32 v210, v210, v51
  v_mul_f32 v211, v211, v51
  v_mul_f32 v212, v212, v51
  v_mul_f32 v213, v213, v51
  v_mul_f32 v214, v214, v51
  v_mul_f32 v215, v215, v51
  v_mul_f32 v216, v216, v51
  v_mul_f32 v217, v217, v51
  v_mul_f32 v218, v218, v51
  v_mul_f32 v219, v219, v51
  v_cvt_pk_bf16_f32 v224, v208, v209
  v_cvt_pk_bf16_f32 v225, v210, v211
  v_cvt_pk_bf16_f32 v226, v212, v213
  v_cvt_pk_bf16_f32 v227, v214, v215
  v_cvt_pk_bf16_f32 v228, v216, v217
  v_cvt_pk_bf16_f32 v229, v218, v219
  v_mov_b32 v230, 0
  v_mov_b32 v231, 0
  v_permlane32_swap_b32 v224, v226
  v_permlane32_swap_b32 v225, v227
  s_lshl_b32 s64, s84, 2
  s_lshr_b32 s65, s52, 1
  s_add_u32 s64, s64, s65
  s_mul_i32 s64, s64, 399360
  s_add_u32 s64, s64, 7864320
  s_and_b32 s65, s52, 1
  s_lshl_b32 s65, s65, 9
  s_add_u32 s64, s64, s65
  s_mul_i32 s65, s85, 3
  s_add_u32 s65, s65, 216
  s_add_u32 s66, s65, 0
  s_lshr_b32 s67, s66, 3
  s_mul_i32 s67, s67, 10240
  s_and_b32 s66, s66, 7
  s_lshl_b32 s66, s66, 10
  s_add_u32 s68, s67, s66
  s_add_u32 s66, s65, 1
  s_lshr_b32 s67, s66, 3
  s_mul_i32 s67, s67, 10240
  s_and_b32 s66, s66, 7
  s_lshl_b32 s66, s66, 10
  s_add_u32 s69, s67, s66
  s_add_u32 s66, s65, 2
  s_lshr_b32 s67, s66, 3
  s_mul_i32 s67, s67, 10240
  s_and_b32 s66, s66, 7
  s_lshl_b32 s66, s66, 10
  s_add_u32 s76, s67, s66
  v_mov_b32 v62, s68
  v_mov_b32 v63, s69
  v_cmp_eq_u32 vcc, 1, v3
  s_nop 1
  v_cndmask_b32 v63, v62, v63, vcc
  v_lshl_add_u32 v63, v2, 4, v63
  buffer_store_dwordx4 v[224:227], v63, s[40:43], s64 offen sc1
  s_nop 1
  v_lshlrev_b32 v63, 4, v2
  s_add_u32 s64, s64, s76
  s_mov_b32 exec_hi, 0
  buffer_store_dwordx4 v[228:231], v63, s[40:43], s64 offen sc1
  s_mov_b64 exec, -1
  s_barrier
  s_mov_b32 s66, 102400
  s_add_u32 s64, s86, s66
  s_add_u32 m0, s70, 92160
  s_nop 0
  buffer_load_dwordx4 v241, s[40:43], s64 offen sc1 lds
  s_cmp_lt_u32 s52, 2
  s_cbranch_scc0 L_g2d6
  s_mov_b32 s66, 102400
  s_add_u32 s64, s87, s66
  s_add_u32 s64, s64, 8192
  s_add_u32 m0, s70, 108544
  s_nop 0
  buffer_load_dwordx4 v241, s[40:43], s64 offen sc1 lds
L_g2d6:
  s_mov_b32 s66, 102400
  s_add_u32 s64, s87, s66
  s_add_u32 m0, s70, 100352
  s_nop 0
  buffer_load_dwordx4 v241, s[40:43], s64 offen sc1 lds
  s_mov_b32 s66, 122880
  s_add_u32 s64, s86, s66
  s_add_u32 m0, s70, 110592
  s_nop 0
  buffer_load_dwordx4 v241, s[40:43], s64 offen sc1 lds
  s_cmp_lt_u32 s52, 2
  s_cbranch_scc0 L_g2d7
  s_mov_b32 s66, 122880
  s_add_u32 s64, s87, s66
  s_add_u32 s64, s64, 8192
  s_add_u32 m0, s70, 126976
  s_nop 0
  buffer_load_dwordx4 v241, s[40:43], s64 offen sc1 lds
L_g2d7:
  s_mov_b32 s66, 122880
  s_add_u32 s64, s87, s66
  s_add_u32 m0, s70, 118784
  s_nop 0
  buffer_load_dwordx4 v241, s[40:43], s64 offen sc1 lds
  v_lshrrev_b32 v6, 4, v0
  v_and_b32 v7, 15, v0
  v_lshlrev_b32 v5, 10, v6
  v_lshl_add_u32 v5, v7, 4, v5
  s_lshl_b32 s64, s54, 12
  s_lshl_b32 s65, s53, 8
  s_add_u32 s64, s64, s65
  v_add_u32 v5, s64, v5
  v_lshrrev_b32 v8, 1, v6
  v_lshlrev_b32 v8, 4, v8
  v_and_b32 v9, 1, v6
  v_lshl_add_u32 v8, v9, 2, v8
  v_bfe_u32 v9, v0, 2, 2
  v_add_u32 v8, v8, v9
  v_mul_u32_u24 v8, 160, v8
  v_and_b32 v9, 3, v0
  v_lshl_add_u32 v8, v9, 3, v8
  s_mul_i32 s64, s54, 5120
  s_add_u32 s64, s64, 8192
  v_add_u32 v4, s64, v8
  v_add_u32 v10, 55296, v4
  v_add_u32 v11, 55296, v5
  v_add_u32 v12, 110592, v4
  v_add_u32 v13, 110592, v5
  s_waitcnt vmcnt(12)
  s_barrier
  ds_read_b128 v[96:99], v5 offset:0
  ds_read_b64_tr_b16 v[100:101], v4 offset:0
  ds_read_b64_tr_b16 v[102:103], v4 offset:1280
  ds_read_b64_tr_b16 v[104:105], v4 offset:32
  ds_read_b64_tr_b16 v[106:107], v4 offset:1312
  ds_read_b64_tr_b16 v[108:109], v4 offset:64
  ds_read_b64_tr_b16 v[110:111], v4 offset:1344
  ds_read_b64_tr_b16 v[112:113], v4 offset:96
  ds_read_b64_tr_b16 v[114:115], v4 offset:1376
  ds_read_b64_tr_b16 v[116:117], v4 offset:128
  ds_read_b64_tr_b16 v[118:119], v4 offset:1408
  ds_read_b128 v[120:123], v5 offset:18432
  ds_read_b64_tr_b16 v[124:125], v4 offset:18432
  ds_read_b64_tr_b16 v[126:127], v4 offset:19712
  ds_read_b64_tr_b16 v[128:129], v4 offset:18464
  ds_read_b64_tr_b16 v[130:131], v4 offset:19744
  ds_read_b64_tr_b16 v[132:133], v4 offset:18496
  ds_read_b64_tr_b16 v[134:135], v4 offset:19776
  ds_read_b64_tr_b16 v[136:137], v4 offset:18528
  ds_read_b64_tr_b16 v[138:139], v4 offset:19808
  ds_read_b64_tr_b16 v[140:141], v4 offset:18560
  ds_read_b64_tr_b16 v[142:143], v4 offset:19840
  s_waitcnt lgkmcnt(11)
  v_mfma_f32_16x16x32_bf16 v[64:67], v[100:103], v[96:99], 0
  v_mfma_f32_16x16x32_bf16 v[68:71], v[104:107], v[96:99], 0
  v_mfma_f32_16x16x32_bf16 v[72:75], v[108:111], v[96:99], 0
  v_mfma_f32_16x16x32_bf16 v[76:79], v[112:115], v[96:99], 0
  v_mfma_f32_16x16x32_bf16 v[80:83], v[116:119], v[96:99], 0
  s_waitcnt vmcnt(8)
  s_waitcnt lgkmcnt(0)
  s_barrier
  ds_read_b128 v[96:99], v5 offset:36864
  ds_read_b64_tr_b16 v[100:101], v4 offset:36864
  ds_read_b64_tr_b16 v[102:103], v4 offset:38144
  ds_read_b64_tr_b16 v[104:105], v4 offset:36896
  ds_read_b64_tr_b16 v[106:107], v4 offset:38176
  ds_read_b64_tr_b16 v[108:109], v4 offset:36928
  ds_read_b64_tr_b16 v[110:111], v4 offset:38208
  ds_read_b64_tr_b16 v[112:113], v4 offset:36960
  ds_read_b64_tr_b16 v[114:115], v4 offset:38240
  ds_read_b64_tr_b16 v[116:117], v4 offset:36992
  ds_read_b64_tr_b16 v[118:119], v4 offset:38272
  s_mov_b32 s66, 143360
  s_add_u32 s64, s86, s66
  s_add_u32 m0, s70, 129024
  s_nop 0
  buffer_load_dwordx4 v241, s[40:43], s64 offen sc1 lds
  v_mfma_f32_16x16x32_bf16 v[64:67], v[124:127], v[120:123], v[64:67]
  v_mfma_f32_16x16x32_bf16 v[68:71], v[128:131], v[120:123], v[68:71]
  s_cmp_lt_u32 s52, 2
  s_cbranch_scc0 L_g2d8
  s_mov_b32 s66, 143360
  s_add_u32 s64, s87, s66
  s_add_u32 s64, s64, 8192
  s_add_u32 m0, s70, 145408
  s_nop 0
  buffer_load_dwordx4 v241, s[40:43], s64 offen sc1 lds
L_g2d8:
  v_mfma_f32_16x16x32_bf16 v[72:75], v[132:135], v[120:123], v[72:75]
  v_mfma_f32_16x16x32_bf16 v[76:79], v[136:139], v[120:123], v[76:79]
  v_mfma_f32_16x16x32_bf16 v[80:83], v[140:143], v[120:123], v[80:83]
  s_mov_b32 s66, 143360
  s_add_u32 s64, s87, s66
  s_add_u32 m0, s70, 137216
  s_nop 0
  buffer_load_dwordx4 v241, s[40:43], s64 offen sc1 lds
  s_mov_b32 s66, 163840
  s_add_u32 s64, s86, s66
  s_add_u32 m0, s70, 0
  s_nop 0
  buffer_load_dwordx4 v241, s[40:43], s64 offen sc1 lds
  s_cmp_lt_u32 s52, 2
  s_cbranch_scc0 L_g2d9
  s_mov_b32 s66, 163840
  s_add_u32 s64, s87, s66
  s_add_u32 s64, s64, 8192
  s_add_u32 m0, s70, 16384
  s_nop 0
  buffer_load_dwordx4 v241, s[40:43], s64 offen sc1 lds
L_g2d9:
  s_mov_b32 s66, 163840
  s_add_u32 s64, s87, s66
  s_add_u32 m0, s70, 8192
  s_nop 0
  buffer_load_dwordx4 v241, s[40:43], s64 offen sc1 lds
  ds_read_b128 v[120:123], v11 offset:0
  ds_read_b64_tr_b16 v[124:125], v10 offset:0
  ds_read_b64_tr_b16 v[126:127], v10 offset:1280
  ds_read_b64_tr_b16 v[128:129], v10 offset:32
  ds_read_b64_tr_b16 v[130:131], v10 offset:1312
  ds_read_b64_tr_b16 v[132:133], v10 offset:64
  ds_read_b64_tr_b16 v[134:135], v10 offset:1344
  ds_read_b64_tr_b16 v[136:137], v10 offset:96
  ds_read_b64_tr_b16 v[138:139], v10 offset:1376
  ds_read_b64_tr_b16 v[140:141], v10 offset:128
  ds_read_b64_tr_b16 v[142:143], v10 offset:1408
  s_mov_b32 s66, 184320
  s_add_u32 s64, s86, s66
  s_add_u32 m0, s70, 18432
  s_nop 0
  buffer_load_dwordx4 v241, s[40:43], s64 offen sc1 lds
  s_waitcnt lgkmcnt(11)
  v_mfma_f32_16x16x32_bf16 v[64:67], v[100:103], v[96:99], v[64:67]
  v_mfma_f32_16x16x32_bf16 v[68:71], v[104:107], v[96:99], v[68:71]
  s_cmp_lt_u32 s52, 2
  s_cbranch_scc0 L_g2d10
  s_mov_b32 s66, 184320
  s_add_u32 s64, s87, s66
  s_add_u32 s64, s64, 8192
  s_add_u32 m0, s70, 34816
  s_nop 0
  buffer_load_dwordx4 v241, s[40:43], s64 offen sc1 lds
L_g2d10:
  v_mfma_f32_16x16x32_bf16 v[72:75], v[108:111], v[96:99], v[72:75]
  v_mfma_f32_16x16x32_bf16 v[76:79], v[112:115], v[96:99], v[76:79]
  v_mfma_f32_16x16x32_bf16 v[80:83], v[116:119], v[96:99], v[80:83]
  s_mov_b32 s66, 184320
  s_add_u32 s64, s87, s66
  s_add_u32 m0, s70, 26624
  s_nop 0
  buffer_load_dwordx4 v241, s[40:43], s64 offen sc1 lds
  s_waitcnt vmcnt(8)
  s_waitcnt lgkmcnt(0)
  s_barrier
  ds_read_b128 v[96:99], v11 offset:18432
  ds_read_b64_tr_b16 v[100:101], v10 offset:18432
  ds_read_b64_tr_b16 v[102:103], v10 offset:19712
  ds_read_b64_tr_b16 v[104:105], v10 offset:18464
  ds_read_b64_tr_b16 v[106:107], v10 offset:19744
  ds_read_b64_tr_b16 v[108:109], v10 offset:18496
  ds_read_b64_tr_b16 v[110:111], v10 offset:19776
  ds_read_b64_tr_b16 v[112:113], v10 offset:18528
  ds_read_b64_tr_b16 v[114:115], v10 offset:19808
  ds_read_b64_tr_b16 v[116:117], v10 offset:18560
  ds_read_b64_tr_b16 v[118:119], v10 offset:19840
  s_mov_b32 s66, 204800
  s_add_u32 s64, s86, s66
  s_add_u32 m0, s70, 36864
  s_nop 0
  buffer_load_dwordx4 v241, s[40:43], s64 offen sc1 lds
  v_mfma_f32_16x16x32_bf16 v[64:67], v[124:127], v[120:123], v[64:67]
  v_mfma_f32_16x16x32_bf16 v[68:71], v[128:131], v[120:123], v[68:71]
  s_cmp_lt_u32 s52, 2
  s_cbranch_scc0 L_g2d11
  s_mov_b32 s66, 204800
  s_add_u32 s64, s87, s66
  s_add_u32 s64, s64, 8192
  s_add_u32 m0, s70, 53248
  s_nop 0
  buffer_load_dwordx4 v241, s[40:43], s64 offen sc1 lds
L_g2d11:
  v_mfma_f32_16x16x32_bf16 v[72:75], v[132:135], v[120:123], v[72:75]
  v_mfma_f32_16x16x32_bf16 v[76:79], v[136:139], v[120:123], v[76:79]
  v_mfma_f32_16x16x32_bf16 v[80:83], v[140:143], v[120:123], v[80:83]
  s_mov_b32 s66, 204800
  s_add_u32 s64, s87, s66
  s_add_u32 m0, s70, 45056
  s_nop 0
  buffer_load_dwordx4 v241, s[40:43], s64 offen sc1 lds
  ds_read_b128 v[120:123], v11 offset:36864
  ds_read_b64_tr_b16 v[124:125], v10 offset:36864
  ds_read_b64_tr_b16 v[126:127], v10 offset:38144
  ds_read_b64_tr_b16 v[128:129], v10 offset:36896
  ds_read_b64_tr_b16 v[130:131], v10 offset:38176
  ds_read_b64_tr_b16 v[132:133], v10 offset:36928
  ds_read_b64_tr_b16 v[134:135], v10 offset:38208
  ds_read_b64_tr_b16 v[136:137], v10 offset:36960
  ds_read_b64_tr_b16 v[138:139], v10 offset:38240
  ds_read_b64_tr_b16 v[140:141], v10 offset:36992
  ds_read_b64_tr_b16 v[142:143], v10 offset:38272
  s_mov_b32 s66, 215040
  s_add_u32 s64, s86, s66
  s_add_u32 m0, s70, 55296
  s_nop 0
  buffer_load_dwordx4 v241, s[40:43], s64 offen sc1 lds
  s_waitcnt lgkmcnt(11)
  v_mfma_f32_16x16x32_bf16 v[64:67], v[100:103], v[96:99], v[64:67]
  v_mfma_f32_16x16x32_bf16 v[68:71], v[104:107], v[96:99], v[68:71]
  s_cmp_lt_u32 s52, 2
  s_cbranch_scc0 L_g2d12
  s_mov_b32 s66, 215040
  s_add_u32 s64, s87, s66
  s_add_u32 s64, s64, 8192
  s_add_u32 m0, s70, 71680
  s_nop 0
  buffer_load_dwordx4 v241, s[40:43], s64 offen sc1 lds
L_g2d12:
  v_mfma_f32_16x16x32_bf16 v[72:75], v[108:111], v[96:99], v[72:75]
  v_mfma_f32_16x16x32_bf16 v[76:79], v[112:115], v[96:99], v[76:79]
  v_mfma_f32_16x16x32_bf16 v[80:83], v[116:119], v[96:99], v[80:83]
  s_mov_b32 s66, 215040
  s_add_u32 s64, s87, s66
  s_add_u32 m0, s70, 63488
  s_nop 0
  buffer_load_dwordx4 v241, s[40:43], s64 offen sc1 lds
  s_waitcnt vmcnt(8)
  s_waitcnt lgkmcnt(0)
  s_barrier
  v_mbcnt_lo_u32_b32 v28, -1, 0
  v_mbcnt_hi_u32_b32 v28, -1, v28
  v_cmp_gt_u32 vcc, 16, v28
  v_mov_b32 v29, 0
  s_nop 0
  v_cndmask_b32 v29, v29, 3, vcc
  v_and_b32 v28, 15, v28
  s_lshr_b32 s64, s61, 1
  s_lshl_b32 s64, s64, 4
  v_add_u32 v28, s64, v28
  v_lshlrev_b32 v28, 7, v28
  v_add_u32 v28, 24068096, v28
  buffer_load_dword v30, v28, s[40:43], 0 offen sc1
  ds_read_b128 v[96:99], v13 offset:0
  ds_read_b64_tr_b16 v[100:101], v12 offset:0
  ds_read_b64_tr_b16 v[102:103], v12 offset:1280
  ds_read_b64_tr_b16 v[104:105], v12 offset:32
  ds_read_b64_tr_b16 v[106:107], v12 offset:1312
  ds_read_b64_tr_b16 v[108:109], v12 offset:64
  ds_read_b64_tr_b16 v[110:111], v12 offset:1344
  ds_read_b64_tr_b16 v[112:113], v12 offset:96
  ds_read_b64_tr_b16 v[114:115], v12 offset:1376
  ds_read_b64_tr_b16 v[116:117], v12 offset:128
  ds_read_b64_tr_b16 v[118:119], v12 offset:1408
  s_mov_b32 s66, 225280
  s_add_u32 s64, s86, s66
  s_add_u32 m0, s70, 73728
  s_nop 0
  buffer_load_dwordx4 v241, s[40:43], s64 offen sc1 lds
  v_mfma_f32_16x16x32_bf16 v[64:67], v[124:127], v[120:123], v[64:67]
  v_mfma_f32_16x16x32_bf16 v[68:71], v[128:131], v[120:123], v[68:71]
  s_cmp_lt_u32 s52, 2
  s_cbranch_scc0 L_g2d13
  s_mov_b32 s66, 225280
  s_add_u32 s64, s87, s66
  s_add_u32 s64, s64, 8192
  s_add_u32 m0, s70, 90112
  s_nop 0
  buffer_load_dwordx4 v241, s[40:43], s64 offen sc1 lds
L_g2d13:
  v_mfma_f32_16x16x32_bf16 v[72:75], v[132:135], v[120:123], v[72:75]
  v_mfma_f32_16x16x32_bf16 v[76:79], v[136:139], v[120:123], v[76:79]
  v_mfma_f32_16x16x32_bf16 v[80:83], v[140:143], v[120:123], v[80:83]
  s_mov_b32 s66, 225280
  s_add_u32 s64, s87, s66
  s_add_u32 m0, s70, 81920
  s_nop 0
  buffer_load_dwordx4 v241, s[40:43], s64 offen sc1 lds
  ds_read_b128 v[120:123], v13 offset:18432
  ds_read_b64_tr_b16 v[124:125], v12 offset:18432
  ds_read_b64_tr_b16 v[126:127], v12 offset:19712
  ds_read_b64_tr_b16 v[128:129], v12 offset:18464
  ds_read_b64_tr_b16 v[130:131], v12 offset:19744
  ds_read_b64_tr_b16 v[132:133], v12 offset:18496
  ds_read_b64_tr_b16 v[134:135], v12 offset:19776
  ds_read_b64_tr_b16 v[136:137], v12 offset:18528
  ds_read_b64_tr_b16 v[138:139], v12 offset:19808
  ds_read_b64_tr_b16 v[140:141], v12 offset:18560
  ds_read_b64_tr_b16 v[142:143], v12 offset:19840
  s_mov_b32 s66, 235520
  s_add_u32 s64, s86, s66
  s_add_u32 m0, s70, 92160
  s_nop 0
  buffer_load_dwordx4 v241, s[40:43], s64 offen sc1 lds
  s_waitcnt lgkmcnt(11)
  v_mfma_f32_16x16x32_bf16 v[64:67], v[100:103], v[96:99], v[64:67]
  v_mfma_f32_16x16x32_bf16 v[68:71], v[104:107], v[96:99], v[68:71]
  s_cmp_lt_u32 s52, 2
  s_cbranch_scc0 L_g2d14
  s_mov_b32 s66, 235520
  s_add_u32 s64, s87, s66
  s_add_u32 s64, s64, 8192
  s_add_u32 m0, s70, 108544
  s_nop 0
  buffer_load_dwordx4 v241, s[40:43], s64 offen sc1 lds
L_g2d14:
  v_mfma_f32_16x16x32_bf16 v[72:75], v[108:111], v[96:99], v[72:75]
  v_mfma_f32_16x16x32_bf16 v[76:79], v[112:115], v[96:99], v[76:79]
  v_mfma_f32_16x16x32_bf16 v[80:83], v[116:119], v[96:99], v[80:83]
  s_mov_b32 s66, 235520
  s_add_u32 s64, s87, s66
  s_add_u32 m0, s70, 100352
  s_nop 0
  buffer_load_dwordx4 v241, s[40:43], s64 offen sc1 lds
  s_waitcnt vmcnt(9)
  v_mov_b32 v14, 163716
  v_mov_b32 v15, 1
  s_mov_b64 exec, 1
  ds_add_rtn_u32 v16, v14, v15
  s_waitcnt lgkmcnt(0)
  s_mov_b64 exec, -1
  v_readfirstlane_b32 s64, v16
  s_nop 0
  s_cmp_eq_u32 s64, 7
  s_cbranch_scc0 L_arr5
  v_mov_b32 v24, 4
  v_mov_b32 v25, 4
  v_mov_b32 v26, 4
  v_mov_b32 v27, 4
  v_mbcnt_lo_u32_b32 v16, -1, 0
  v_lshlrev_b32 v16, 4, v16
  s_lshl_b32 s64, s60, 7
  s_add_u32 s64, s64, 24068096
  s_mov_b64 s[72:73], exec
  s_mov_b64 exec, 0xff
  buffer_store_dwordx4 v[24:27], v16, s[40:43], s64 offen sc1
  s_mov_b64 exec, s[72:73]
L_pub4_4710:
L_arr5:
  s_cmp_eq_u32 s52, 0
  s_cbranch_scc0 L_bf_ok
  s_mov_b32 s79, 0
  s_branch L_wfc6
L_wf6:
  buffer_load_dword v30, v28, s[40:43], 0 offen sc1
  s_waitcnt vmcnt(0)
L_wfc6:
  v_cmp_lt_u32 vcc, v30, v29
  s_nop 0
  s_cbranch_vccz L_wfok6
L_wfs6:
  s_sleep 8
  s_add_u32 s79, s79, 1
  s_cmp_lt_u32 s79, 0x40000
  s_cbranch_scc1 L_wf6
L_wfok6:
L_bf_ok:
  s_waitcnt lgkmcnt(0)
  s_barrier
  ds_read_b128 v[96:99], v5 offset:0
  ds_read_b64_tr_b16 v[100:101], v4 offset:0
  ds_read_b64_tr_b16 v[102:103], v4 offset:1280
  ds_read_b64_tr_b16 v[104:105], v4 offset:32
  ds_read_b64_tr_b16 v[106:107], v4 offset:1312
  ds_read_b64_tr_b16 v[108:109], v4 offset:64
  ds_read_b64_tr_b16 v[110:111], v4 offset:1344
  ds_read_b64_tr_b16 v[112:113], v4 offset:96
  ds_read_b64_tr_b16 v[114:115], v4 offset:1376
  ds_read_b64_tr_b16 v[116:117], v4 offset:128
  ds_read_b64_tr_b16 v[118:119], v4 offset:1408
  s_mov_b32 s66, 245760
  s_add_u32 s64, s86, s66
  s_add_u32 m0, s70, 110592
  s_nop 0
  buffer_load_dwordx4 v241, s[40:43], s64 offen sc1 lds
  v_mfma_f32_16x16x32_bf16 v[64:67], v[124:127], v[120:123], v[64:67]
  v_mfma_f32_16x16x32_bf16 v[68:71], v[128:131], v[120:123], v[68:71]
  s_cmp_lt_u32 s52, 2
  s_cbranch_scc0 L_g2d15
  s_mov_b32 s66, 245760
  s_add_u32 s64, s87, s66
  s_add_u32 s64, s64, 8192
  s_add_u32 m0, s70, 126976
  s_nop 0
  buffer_load_dwordx4 v241, s[40:43], s64 offen sc1 lds
L_g2d15:
  v_mfma_f32_16x16x32_bf16 v[72:75], v[132:135], v[120:123], v[72:75]
  v_mfma_f32_16x16x32_bf16 v[76:79], v[136:139], v[120:123], v[76:79]
  v_mfma_f32_16x16x32_bf16 v[80:83], v[140:143], v[120:123], v[80:83]
  s_mov_b32 s66, 245760
  s_add_u32 s64, s87, s66
  s_add_u32 m0, s70, 118784
  s_nop 0
  buffer_load_dwordx4 v241, s[40:43], s64 offen sc1 lds
  ds_read_b128 v[120:123], v5 offset:18432
  ds_read_b64_tr_b16 v[124:125], v4 offset:18432
  ds_read_b64_tr_b16 v[126:127], v4 offset:19712
  ds_read_b64_tr_b16 v[128:129], v4 offset:18464
  ds_read_b64_tr_b16 v[130:131], v4 offset:19744
  ds_read_b64_tr_b16 v[132:133], v4 offset:18496
  ds_read_b64_tr_b16 v[134:135], v4 offset:19776
  ds_read_b64_tr_b16 v[136:137], v4 offset:18528
  ds_read_b64_tr_b16 v[138:139], v4 offset:19808
  ds_read_b64_tr_b16 v[140:141], v4 offset:18560
  ds_read_b64_tr_b16 v[142:143], v4 offset:19840
  s_mov_b32 s66, 256000
  s_add_u32 s64, s86, s66
  s_add_u32 m0, s70, 129024
  s_nop 0
  buffer_load_dwordx4 v241, s[40:43], s64 offen sc1 lds
  s_waitcnt lgkmcnt(11)
  v_mfma_f32_16x16x32_bf16 v[64:67], v[100:103], v[96:99], v[64:67]
  v_mfma_f32_16x16x32_bf16 v[68:71], v[104:107], v[96:99], v[68:71]
  s_cmp_lt_u32 s52, 2
  s_cbranch_scc0 L_g2d16
  s_mov_b32 s66, 256000
  s_add_u32 s64, s87, s66
  s_add_u32 s64, s64, 8192
  s_add_u32 m0, s70, 145408
  s_nop 0
  buffer_load_dwordx4 v241, s[40:43], s64 offen sc1 lds
L_g2d16:
  v_mfma_f32_16x16x32_bf16 v[72:75], v[108:111], v[96:99], v[72:75]
  v_mfma_f32_16x16x32_bf16 v[76:79], v[112:115], v[96:99], v[76:79]
  v_mfma_f32_16x16x32_bf16 v[80:83], v[116:119], v[96:99], v[80:83]
  s_mov_b32 s66, 256000
  s_add_u32 s64, s87, s66
  s_add_u32 m0, s70, 137216
  s_nop 0
  buffer_load_dwordx4 v241, s[40:43], s64 offen sc1 lds
  s_waitcnt vmcnt(9)
  s_waitcnt lgkmcnt(0)
  s_barrier
  ds_read_b128 v[96:99], v5 offset:36864
  ds_read_b64_tr_b16 v[100:101], v4 offset:36864
  ds_read_b64_tr_b16 v[102:103], v4 offset:38144
  ds_read_b64_tr_b16 v[104:105], v4 offset:36896
  ds_read_b64_tr_b16 v[106:107], v4 offset:38176
  ds_read_b64_tr_b16 v[108:109], v4 offset:36928
  ds_read_b64_tr_b16 v[110:111], v4 offset:38208
  ds_read_b64_tr_b16 v[112:113], v4 offset:36960
  ds_read_b64_tr_b16 v[114:115], v4 offset:38240
  ds_read_b64_tr_b16 v[116:117], v4 offset:36992
  ds_read_b64_tr_b16 v[118:119], v4 offset:38272
  s_mov_b32 s66, 10240
  s_add_u32 s64, s86, s66
  s_add_u32 m0, s70, 0
  s_nop 0
  buffer_load_dwordx4 v241, s[40:43], s64 offen sc1 lds
  v_mfma_f32_16x16x32_bf16 v[64:67], v[124:127], v[120:123], v[64:67]
  v_mfma_f32_16x16x32_bf16 v[68:71], v[128:131], v[120:123], v[68:71]
  s_cmp_lt_u32 s52, 2
  s_cbranch_scc0 L_g2d17
  s_mov_b32 s66, 10240
  s_add_u32 s64, s87, s66
  s_add_u32 s64, s64, 8192
  s_add_u32 m0, s70, 16384
  s_nop 0
  buffer_load_dwordx4 v241, s[40:43], s64 offen sc1 lds
L_g2d17:
  v_mfma_f32_16x16x32_bf16 v[72:75], v[132:135], v[120:123], v[72:75]
  v_mfma_f32_16x16x32_bf16 v[76:79], v[136:139], v[120:123], v[76:79]
  v_mfma_f32_16x16x32_bf16 v[80:83], v[140:143], v[120:123], v[80:83]
  s_mov_b32 s66, 10240
  s_add_u32 s64, s87, s66
  s_add_u32 m0, s70, 8192
  s_nop 0
  buffer_load_dwordx4 v241, s[40:43], s64 offen sc1 lds
  ds_read_b128 v[120:123], v11 offset:0
  ds_read_b64_tr_b16 v[124:125], v10 offset:0
  ds_read_b64_tr_b16 v[126:127], v10 offset:1280
  ds_read_b64_tr_b16 v[128:129], v10 offset:32
  ds_read_b64_tr_b16 v[130:131], v10 offset:1312
  ds_read_b64_tr_b16 v[132:133], v10 offset:64
  ds_read_b64_tr_b16 v[134:135], v10 offset:1344
  ds_read_b64_tr_b16 v[136:137], v10 offset:96
  ds_read_b64_tr_b16 v[138:139], v10 offset:1376
  ds_read_b64_tr_b16 v[140:141], v10 offset:128
  ds_read_b64_tr_b16 v[142:143], v10 offset:1408
  s_mov_b32 s66, 30720
  s_add_u32 s64, s86, s66
  s_add_u32 m0, s70, 18432
  s_nop 0
  buffer_load_dwordx4 v241, s[40:43], s64 offen sc1 lds
  s_waitcnt lgkmcnt(11)
  v_mfma_f32_16x16x32_bf16 v[64:67], v[100:103], v[96:99], v[64:67]
  v_mfma_f32_16x16x32_bf16 v[68:71], v[104:107], v[96:99], v[68:71]
  s_cmp_lt_u32 s52, 2
  s_cbranch_scc0 L_g2d18
  s_mov_b32 s66, 30720
  s_add_u32 s64, s87, s66
  s_add_u32 s64, s64, 8192
  s_add_u32 m0, s70, 34816
  s_nop 0
  buffer_load_dwordx4 v241, s[40:43], s64 offen sc1 lds
L_g2d18:
  v_mfma_f32_16x16x32_bf16 v[72:75], v[108:111], v[96:99], v[72:75]
  v_mfma_f32_16x16x32_bf16 v[76:79], v[112:115], v[96:99], v[76:79]
  v_mfma_f32_16x16x32_bf16 v[80:83], v[116:119], v[96:99], v[80:83]
  s_mov_b32 s66, 30720
  s_add_u32 s64, s87, s66
  s_add_u32 m0, s70, 26624
  s_nop 0
  buffer_load_dwordx4 v241, s[40:43], s64 offen sc1 lds
  s_waitcnt vmcnt(8)
  s_waitcnt lgkmcnt(0)
  s_barrier
  ds_read_b128 v[96:99], v11 offset:18432
  ds_read_b64_tr_b16 v[100:101], v10 offset:18432
  ds_read_b64_tr_b16 v[102:103], v10 offset:19712
  ds_read_b64_tr_b16 v[104:105], v10 offset:18464
  ds_read_b64_tr_b16 v[106:107], v10 offset:19744
  ds_read_b64_tr_b16 v[108:109], v10 offset:18496
  ds_read_b64_tr_b16 v[110:111], v10 offset:19776
  ds_read_b64_tr_b16 v[112:113], v10 offset:18528
  ds_read_b64_tr_b16 v[114:115], v10 offset:19808
  ds_read_b64_tr_b16 v[116:117], v10 offset:18560
  ds_read_b64_tr_b16 v[118:119], v10 offset:19840
  s_mov_b32 s66, 51200
  s_add_u32 s64, s86, s66
  s_add_u32 m0, s70, 36864
  s_nop 0
  buffer_load_dwordx4 v241, s[40:43], s64 offen sc1 lds
  v_mfma_f32_16x16x32_bf16 v[64:67], v[124:127], v[120:123], v[64:67]
  v_mfma_f32_16x16x32_bf16 v[68:71], v[128:131], v[120:123], v[68:71]
  s_cmp_lt_u32 s52, 2
  s_cbranch_scc0 L_g2d19
  s_mov_b32 s66, 51200
  s_add_u32 s64, s87, s66
  s_add_u32 s64, s64, 8192
  s_add_u32 m0, s70, 53248
  s_nop 0
  buffer_load_dwordx4 v241, s[40:43], s64 offen sc1 lds
L_g2d19:
  v_mfma_f32_16x16x32_bf16 v[72:75], v[132:135], v[120:123], v[72:75]
  v_mfma_f32_16x16x32_bf16 v[76:79], v[136:139], v[120:123], v[76:79]
  v_mfma_f32_16x16x32_bf16 v[80:83], v[140:143], v[120:123], v[80:83]
  s_mov_b32 s66, 51200
  s_add_u32 s64, s87, s66
  s_add_u32 m0, s70, 45056
  s_nop 0
  buffer_load_dwordx4 v241, s[40:43], s64 offen sc1 lds
  ds_read_b128 v[120:123], v11 offset:36864
  ds_read_b64_tr_b16 v[124:125], v10 offset:36864
  ds_read_b64_tr_b16 v[126:127], v10 offset:38144
  ds_read_b64_tr_b16 v[128:129], v10 offset:36896
  ds_read_b64_tr_b16 v[130:131], v10 offset:38176
  ds_read_b64_tr_b16 v[132:133], v10 offset:36928
  ds_read_b64_tr_b16 v[134:135], v10 offset:38208
  ds_read_b64_tr_b16 v[136:137], v10 offset:36960
  ds_read_b64_tr_b16 v[138:139], v10 offset:38240
  ds_read_b64_tr_b16 v[140:141], v10 offset:36992
  ds_read_b64_tr_b16 v[142:143], v10 offset:38272
  s_mov_b32 s66, 71680
  s_add_u32 s64, s86, s66
  s_add_u32 m0, s70, 55296
  s_nop 0
  buffer_load_dwordx4 v241, s[40:43], s64 offen sc1 lds
  s_waitcnt lgkmcnt(11)
  v_mfma_f32_16x16x32_bf16 v[64:67], v[100:103], v[96:99], v[64:67]
  v_mfma_f32_16x16x32_bf16 v[68:71], v[104:107], v[96:99], v[68:71]
  s_cmp_lt_u32 s52, 2
  s_cbranch_scc0 L_g2d20
  s_mov_b32 s66, 71680
  s_add_u32 s64, s87, s66
  s_add_u32 s64, s64, 8192
  s_add_u32 m0, s70, 71680
  s_nop 0
  buffer_load_dwordx4 v241, s[40:43], s64 offen sc1 lds
L_g2d20:
  v_mfma_f32_16x16x32_bf16 v[72:75], v[108:111], v[96:99], v[72:75]
  v_mfma_f32_16x16x32_bf16 v[76:79], v[112:115], v[96:99], v[76:79]
  v_mfma_f32_16x16x32_bf16 v[80:83], v[116:119], v[96:99], v[80:83]
  s_mov_b32 s66, 71680
  s_add_u32 s64, s87, s66
  s_add_u32 m0, s70, 63488
  s_nop 0
  buffer_load_dwordx4 v241, s[40:43], s64 offen sc1 lds
  s_waitcnt vmcnt(8)
  s_waitcnt lgkmcnt(0)
  s_barrier
  ds_read_b128 v[96:99], v13 offset:0
  ds_read_b64_tr_b16 v[100:101], v12 offset:0
  ds_read_b64_tr_b16 v[102:103], v12 offset:1280
  ds_read_b64_tr_b16 v[104:105], v12 offset:32
  ds_read_b64_tr_b16 v[106:107], v12 offset:1312
  ds_read_b64_tr_b16 v[108:109], v12 offset:64
  ds_read_b64_tr_b16 v[110:111], v12 offset:1344
  ds_read_b64_tr_b16 v[112:113], v12 offset:96
  ds_read_b64_tr_b16 v[114:115], v12 offset:1376
  ds_read_b64_tr_b16 v[116:117], v12 offset:128
  ds_read_b64_tr_b16 v[118:119], v12 offset:1408
  s_mov_b32 s66, 92160
  s_add_u32 s64, s86, s66
  s_add_u32 m0, s70, 73728
  s_nop 0
  buffer_load_dwordx4 v241, s[40:43], s64 offen sc1 lds
  v_mfma_f32_16x16x32_bf16 v[64:67], v[124:127], v[120:123], v[64:67]
  v_mfma_f32_16x16x32_bf16 v[68:71], v[128:131], v[120:123], v[68:71]
  s_cmp_lt_u32 s52, 2
  s_cbranch_scc0 L_g2d21
  s_mov_b32 s66, 92160
  s_add_u32 s64, s87, s66
  s_add_u32 s64, s64, 8192
  s_add_u32 m0, s70, 90112
  s_nop 0
  buffer_load_dwordx4 v241, s[40:43], s64 offen sc1 lds
L_g2d21:
  v_mfma_f32_16x16x32_bf16 v[72:75], v[132:135], v[120:123], v[72:75]
  v_mfma_f32_16x16x32_bf16 v[76:79], v[136:139], v[120:123], v[76:79]
  v_mfma_f32_16x16x32_bf16 v[80:83], v[140:143], v[120:123], v[80:83]
  s_mov_b32 s66, 92160
  s_add_u32 s64, s87, s66
  s_add_u32 m0, s70, 81920
  s_nop 0
  buffer_load_dwordx4 v241, s[40:43], s64 offen sc1 lds
  ds_read_b128 v[120:123], v13 offset:18432
  ds_read_b64_tr_b16 v[124:125], v12 offset:18432
  ds_read_b64_tr_b16 v[126:127], v12 offset:19712
  ds_read_b64_tr_b16 v[128:129], v12 offset:18464
  ds_read_b64_tr_b16 v[130:131], v12 offset:19744
  ds_read_b64_tr_b16 v[132:133], v12 offset:18496
  ds_read_b64_tr_b16 v[134:135], v12 offset:19776
  ds_read_b64_tr_b16 v[136:137], v12 offset:18528
  ds_read_b64_tr_b16 v[138:139], v12 offset:19808
  ds_read_b64_tr_b16 v[140:141], v12 offset:18560
  ds_read_b64_tr_b16 v[142:143], v12 offset:19840
  s_mov_b32 s66, 112640
  s_add_u32 s64, s86, s66
  s_add_u32 m0, s70, 92160
  s_nop 0
  buffer_load_dwordx4 v241, s[40:43], s64 offen sc1 lds
  s_waitcnt lgkmcnt(11)
  v_mfma_f32_16x16x32_bf16 v[64:67], v[100:103], v[96:99], v[64:67]
  v_mfma_f32_16x16x32_bf16 v[68:71], v[104:107], v[96:99], v[68:71]
  s_cmp_lt_u32 s52, 2
  s_cbranch_scc0 L_g2d22
  s_mov_b32 s66, 112640
  s_add_u32 s64, s87, s66
  s_add_u32 s64, s64, 8192
  s_add_u32 m0, s70, 108544
  s_nop 0
  buffer_load_dwordx4 v241, s[40:43], s64 offen sc1 lds
L_g2d22:
  v_mfma_f32_16x16x32_bf16 v[72:75], v[108:111], v[96:99], v[72:75]
  v_mfma_f32_16x16x32_bf16 v[76:79], v[112:115], v[96:99], v[76:79]
  v_mfma_f32_16x16x32_bf16 v[80:83], v[116:119], v[96:99], v[80:83]
  s_mov_b32 s66, 112640
  s_add_u32 s64, s87, s66
  s_add_u32 m0, s70, 100352
  s_nop 0
  buffer_load_dwordx4 v241, s[40:43], s64 offen sc1 lds
  s_waitcnt vmcnt(8)
  s_waitcnt lgkmcnt(0)
  s_barrier
  ds_read_b128 v[96:99], v5 offset:0
  ds_read_b64_tr_b16 v[100:101], v4 offset:0
  ds_read_b64_tr_b16 v[102:103], v4 offset:1280
  ds_read_b64_tr_b16 v[104:105], v4 offset:32
  ds_read_b64_tr_b16 v[106:107], v4 offset:1312
  ds_read_b64_tr_b16 v[108:109], v4 offset:64
  ds_read_b64_tr_b16 v[110:111], v4 offset:1344
  ds_read_b64_tr_b16 v[112:113], v4 offset:96
  ds_read_b64_tr_b16 v[114:115], v4 offset:1376
  ds_read_b64_tr_b16 v[116:117], v4 offset:128
  ds_read_b64_tr_b16 v[118:119], v4 offset:1408
  s_mov_b32 s66, 133120
  s_add_u32 s64, s86, s66
  s_add_u32 m0, s70, 110592
  s_nop 0
  buffer_load_dwordx4 v241, s[40:43], s64 offen sc1 lds
  v_mfma_f32_16x16x32_bf16 v[64:67], v[124:127], v[120:123], v[64:67]
  v_mfma_f32_16x16x32_bf16 v[68:71], v[128:131], v[120:123], v[68:71]
  s_cmp_lt_u32 s52, 2
  s_cbranch_scc0 L_g2d23
  s_mov_b32 s66, 133120
  s_add_u32 s64, s87, s66
  s_add_u32 s64, s64, 8192
  s_add_u32 m0, s70, 126976
  s_nop 0
  buffer_load_dwordx4 v241, s[40:43], s64 offen sc1 lds
L_g2d23:
  v_mfma_f32_16x16x32_bf16 v[72:75], v[132:135], v[120:123], v[72:75]
  v_mfma_f32_16x16x32_bf16 v[76:79], v[136:139], v[120:123], v[76:79]
  v_mfma_f32_16x16x32_bf16 v[80:83], v[140:143], v[120:123], v[80:83]
  s_mov_b32 s66, 133120
  s_add_u32 s64, s87, s66
  s_add_u32 m0, s70, 118784
  s_nop 0
  buffer_load_dwordx4 v241, s[40:43], s64 offen sc1 lds
  ds_read_b128 v[120:123], v5 offset:18432
  ds_read_b64_tr_b16 v[124:125], v4 offset:18432
  ds_read_b64_tr_b16 v[126:127], v4 offset:19712
  ds_read_b64_tr_b16 v[128:129], v4 offset:18464
  ds_read_b64_tr_b16 v[130:131], v4 offset:19744
  ds_read_b64_tr_b16 v[132:133], v4 offset:18496
  ds_read_b64_tr_b16 v[134:135], v4 offset:19776
  ds_read_b64_tr_b16 v[136:137], v4 offset:18528
  ds_read_b64_tr_b16 v[138:139], v4 offset:19808
  ds_read_b64_tr_b16 v[140:141], v4 offset:18560
  ds_read_b64_tr_b16 v[142:143], v4 offset:19840
  s_mov_b32 s66, 153600
  s_add_u32 s64, s86, s66
  s_add_u32 m0, s70, 129024
  s_nop 0
  buffer_load_dwordx4 v241, s[40:43], s64 offen sc1 lds
  s_waitcnt lgkmcnt(11)
  v_mfma_f32_16x16x32_bf16 v[64:67], v[100:103], v[96:99], v[64:67]
  v_mfma_f32_16x16x32_bf16 v[68:71], v[104:107], v[96:99], v[68:71]
  s_cmp_lt_u32 s52, 2
  s_cbranch_scc0 L_g2d24
  s_mov_b32 s66, 153600
  s_add_u32 s64, s87, s66
  s_add_u32 s64, s64, 8192
  s_add_u32 m0, s70, 145408
  s_nop 0
  buffer_load_dwordx4 v241, s[40:43], s64 offen sc1 lds
L_g2d24:
  v_mfma_f32_16x16x32_bf16 v[72:75], v[108:111], v[96:99], v[72:75]
  v_mfma_f32_16x16x32_bf16 v[76:79], v[112:115], v[96:99], v[76:79]
  v_mfma_f32_16x16x32_bf16 v[80:83], v[116:119], v[96:99], v[80:83]
  s_mov_b32 s66, 153600
  s_add_u32 s64, s87, s66
  s_add_u32 m0, s70, 137216
  s_nop 0
  buffer_load_dwordx4 v241, s[40:43], s64 offen sc1 lds
  s_waitcnt vmcnt(8)
  s_waitcnt lgkmcnt(0)
  s_barrier
  v_mbcnt_lo_u32_b32 v20, -1, 0
  v_mbcnt_hi_u32_b32 v20, -1, v20
  v_cmp_gt_u32 vcc, 32, v20
  v_mov_b32 v21, 0
  s_nop 0
  v_cndmask_b32 v21, v21, 4, vcc
  v_and_b32 v20, 31, v20
  s_lshr_b32 s64, s61, 2
  s_lshl_b32 s64, s64, 5
  v_add_u32 v20, s64, v20
  v_lshlrev_b32 v20, 7, v20
  v_add_u32 v20, 24068096, v20
  buffer_load_dword v22, v20, s[40:43], 0 offen sc1
  ds_read_b128 v[96:99], v5 offset:36864
  ds_read_b64_tr_b16 v[100:101], v4 offset:36864
  ds_read_b64_tr_b16 v[102:103], v4 offset:38144
  ds_read_b64_tr_b16 v[104:105], v4 offset:36896
  ds_read_b64_tr_b16 v[106:107], v4 offset:38176
  ds_read_b64_tr_b16 v[108:109], v4 offset:36928
  ds_read_b64_tr_b16 v[110:111], v4 offset:38208
  ds_read_b64_tr_b16 v[112:113], v4 offset:36960
  ds_read_b64_tr_b16 v[114:115], v4 offset:38240
  ds_read_b64_tr_b16 v[116:117], v4 offset:36992
  ds_read_b64_tr_b16 v[118:119], v4 offset:38272
  s_mov_b32 s66, 174080
  s_add_u32 s64, s86, s66
  s_add_u32 m0, s70, 0
  s_nop 0
  buffer_load_dwordx4 v241, s[40:43], s64 offen sc1 lds
  v_mfma_f32_16x16x32_bf16 v[64:67], v[124:127], v[120:123], v[64:67]
  v_mfma_f32_16x16x32_bf16 v[68:71], v[128:131], v[120:123], v[68:71]
  s_cmp_lt_u32 s52, 2
  s_cbranch_scc0 L_g2d25
  s_mov_b32 s66, 174080
  s_add_u32 s64, s87, s66
  s_add_u32 s64, s64, 8192
  s_add_u32 m0, s70, 16384
  s_nop 0
  buffer_load_dwordx4 v241, s[40:43], s64 offen sc1 lds
L_g2d25:
  v_mfma_f32_16x16x32_bf16 v[72:75], v[132:135], v[120:123], v[72:75]
  v_mfma_f32_16x16x32_bf16 v[76:79], v[136:139], v[120:123], v[76:79]
  v_mfma_f32_16x16x32_bf16 v[80:83], v[140:143], v[120:123], v[80:83]
  s_mov_b32 s66, 174080
  s_add_u32 s64, s87, s66
  s_add_u32 m0, s70, 8192
  s_nop 0
  buffer_load_dwordx4 v241, s[40:43], s64 offen sc1 lds
  ds_read_b128 v[120:123], v11 offset:0
  ds_read_b64_tr_b16 v[124:125], v10 offset:0
  ds_read_b64_tr_b16 v[126:127], v10 offset:1280
  ds_read_b64_tr_b16 v[128:129], v10 offset:32
  ds_read_b64_tr_b16 v[130:131], v10 offset:1312
  ds_read_b64_tr_b16 v[132:133], v10 offset:64
  ds_read_b64_tr_b16 v[134:135], v10 offset:1344
  ds_read_b64_tr_b16 v[136:137], v10 offset:96
  ds_read_b64_tr_b16 v[138:139], v10 offset:1376
  ds_read_b64_tr_b16 v[140:141], v10 offset:128
  ds_read_b64_tr_b16 v[142:143], v10 offset:1408
  s_mov_b32 s66, 194560
  s_add_u32 s64, s86, s66
  s_add_u32 m0, s70, 18432
  s_nop 0
  buffer_load_dwordx4 v241, s[40:43], s64 offen sc1 lds
  s_waitcnt lgkmcnt(11)
  v_mfma_f32_16x16x32_bf16 v[64:67], v[100:103], v[96:99], v[64:67]
  v_mfma_f32_16x16x32_bf16 v[68:71], v[104:107], v[96:99], v[68:71]
  s_cmp_lt_u32 s52, 2
  s_cbranch_scc0 L_g2d26
  s_mov_b32 s66, 194560
  s_add_u32 s64, s87, s66
  s_add_u32 s64, s64, 8192
  s_add_u32 m0, s70, 34816
  s_nop 0
  buffer_load_dwordx4 v241, s[40:43], s64 offen sc1 lds
L_g2d26:
  v_mfma_f32_16x16x32_bf16 v[72:75], v[108:111], v[96:99], v[72:75]
  v_mfma_f32_16x16x32_bf16 v[76:79], v[112:115], v[96:99], v[76:79]
  v_mfma_f32_16x16x32_bf16 v[80:83], v[116:119], v[96:99], v[80:83]
  s_mov_b32 s66, 194560
  s_add_u32 s64, s87, s66
  s_add_u32 m0, s70, 26624
  s_nop 0
  buffer_load_dwordx4 v241, s[40:43], s64 offen sc1 lds
  s_waitcnt vmcnt(9)
  s_cmp_eq_u32 s52, 0
  s_cbranch_scc0 L_of_ok
  s_mov_b32 s79, 0
  s_branch L_wfc7
L_wf7:
  buffer_load_dword v22, v20, s[40:43], 0 offen sc1
  s_waitcnt vmcnt(0)
L_wfc7:
  v_cmp_lt_u32 vcc, v22, v21
  s_nop 0
  s_cbranch_vccz L_wfok7
L_wfs7:
  s_sleep 8
  s_add_u32 s79, s79, 1
  s_cmp_lt_u32 s79, 0x40000
  s_cbranch_scc1 L_wf7
L_wfok7:
L_of_ok:
  s_waitcnt lgkmcnt(0)
  s_barrier
  ds_read_b128 v[96:99], v11 offset:18432
  ds_read_b64_tr_b16 v[100:101], v10 offset:18432
  ds_read_b64_tr_b16 v[102:103], v10 offset:19712
  ds_read_b64_tr_b16 v[104:105], v10 offset:18464
  ds_read_b64_tr_b16 v[106:107], v10 offset:19744
  ds_read_b64_tr_b16 v[108:109], v10 offset:18496
  ds_read_b64_tr_b16 v[110:111], v10 offset:19776
  ds_read_b64_tr_b16 v[112:113], v10 offset:18528
  ds_read_b64_tr_b16 v[114:115], v10 offset:19808
  ds_read_b64_tr_b16 v[116:117], v10 offset:18560
  ds_read_b64_tr_b16 v[118:119], v10 offset:19840
  s_mov_b32 s66, 266240
  s_add_u32 s64, s86, s66
  s_add_u32 m0, s70, 36864
  s_nop 0
  buffer_load_dwordx4 v241, s[40:43], s64 offen sc1 lds
  v_mfma_f32_16x16x32_bf16 v[64:67], v[124:127], v[120:123], v[64:67]
  v_mfma_f32_16x16x32_bf16 v[68:71], v[128:131], v[120:123], v[68:71]
  s_cmp_lt_u32 s52, 2
  s_cbranch_scc0 L_g2d27
  s_mov_b32 s66, 266240
  s_add_u32 s64, s87, s66
  s_add_u32 s64, s64, 8192
  s_add_u32 m0, s70, 53248
  s_nop 0
  buffer_load_dwordx4 v241, s[40:43], s64 offen sc1 lds
L_g2d27:
  v_mfma_f32_16x16x32_bf16 v[72:75], v[132:135], v[120:123], v[72:75]
  v_mfma_f32_16x16x32_bf16 v[76:79], v[136:139], v[120:123], v[76:79]
  v_mfma_f32_16x16x32_bf16 v[80:83], v[140:143], v[120:123], v[80:83]
  s_mov_b32 s66, 266240
  s_add_u32 s64, s87, s66
  s_add_u32 m0, s70, 45056
  s_nop 0
  buffer_load_dwordx4 v241, s[40:43], s64 offen sc1 lds
  ds_read_b128 v[120:123], v11 offset:36864
  ds_read_b64_tr_b16 v[124:125], v10 offset:36864
  ds_read_b64_tr_b16 v[126:127], v10 offset:38144
  ds_read_b64_tr_b16 v[128:129], v10 offset:36896
  ds_read_b64_tr_b16 v[130:131], v10 offset:38176
  ds_read_b64_tr_b16 v[132:133], v10 offset:36928
  ds_read_b64_tr_b16 v[134:135], v10 offset:38208
  ds_read_b64_tr_b16 v[136:137], v10 offset:36960
  ds_read_b64_tr_b16 v[138:139], v10 offset:38240
  ds_read_b64_tr_b16 v[140:141], v10 offset:36992
  ds_read_b64_tr_b16 v[142:143], v10 offset:38272
  s_mov_b32 s66, 276480
  s_add_u32 s64, s86, s66
  s_add_u32 m0, s70, 55296
  s_nop 0
  buffer_load_dwordx4 v241, s[40:43], s64 offen sc1 lds
  s_waitcnt lgkmcnt(11)
  v_mfma_f32_16x16x32_bf16 v[64:67], v[100:103], v[96:99], v[64:67]
  v_mfma_f32_16x16x32_bf16 v[68:71], v[104:107], v[96:99], v[68:71]
  s_cmp_lt_u32 s52, 2
  s_cbranch_scc0 L_g2d28
  s_mov_b32 s66, 276480
  s_add_u32 s64, s87, s66
  s_add_u32 s64, s64, 8192
  s_add_u32 m0, s70, 71680
  s_nop 0
  buffer_load_dwordx4 v241, s[40:43], s64 offen sc1 lds
L_g2d28:
  v_mfma_f32_16x16x32_bf16 v[72:75], v[108:111], v[96:99], v[72:75]
  v_mfma_f32_16x16x32_bf16 v[76:79], v[112:115], v[96:99], v[76:79]
  v_mfma_f32_16x16x32_bf16 v[80:83], v[116:119], v[96:99], v[80:83]
  s_mov_b32 s66, 276480
  s_add_u32 s64, s87, s66
  s_add_u32 m0, s70, 63488
  s_nop 0
  buffer_load_dwordx4 v241, s[40:43], s64 offen sc1 lds
  s_waitcnt vmcnt(9)
  s_waitcnt lgkmcnt(0)
  s_barrier
  ds_read_b128 v[96:99], v13 offset:0
  ds_read_b64_tr_b16 v[100:101], v12 offset:0
  ds_read_b64_tr_b16 v[102:103], v12 offset:1280
  ds_read_b64_tr_b16 v[104:105], v12 offset:32
  ds_read_b64_tr_b16 v[106:107], v12 offset:1312
  ds_read_b64_tr_b16 v[108:109], v12 offset:64
  ds_read_b64_tr_b16 v[110:111], v12 offset:1344
  ds_read_b64_tr_b16 v[112:113], v12 offset:96
  ds_read_b64_tr_b16 v[114:115], v12 offset:1376
  ds_read_b64_tr_b16 v[116:117], v12 offset:128
  ds_read_b64_tr_b16 v[118:119], v12 offset:1408
  s_mov_b32 s66, 286720
  s_add_u32 s64, s86, s66
  s_add_u32 m0, s70, 73728
  s_nop 0
  buffer_load_dwordx4 v241, s[40:43], s64 offen sc1 lds
  v_mfma_f32_16x16x32_bf16 v[64:67], v[124:127], v[120:123], v[64:67]
  v_mfma_f32_16x16x32_bf16 v[68:71], v[128:131], v[120:123], v[68:71]
  s_cmp_lt_u32 s52, 2
  s_cbranch_scc0 L_g2d29
  s_mov_b32 s66, 286720
  s_add_u32 s64, s87, s66
  s_add_u32 s64, s64, 8192
  s_add_u32 m0, s70, 90112
  s_nop 0
  buffer_load_dwordx4 v241, s[40:43], s64 offen sc1 lds
L_g2d29:
  v_mfma_f32_16x16x32_bf16 v[72:75], v[132:135], v[120:123], v[72:75]
  v_mfma_f32_16x16x32_bf16 v[76:79], v[136:139], v[120:123], v[76:79]
  v_mfma_f32_16x16x32_bf16 v[80:83], v[140:143], v[120:123], v[80:83]
  s_mov_b32 s66, 286720
  s_add_u32 s64, s87, s66
  s_add_u32 m0, s70, 81920
  s_nop 0
  buffer_load_dwordx4 v241, s[40:43], s64 offen sc1 lds
  ds_read_b128 v[120:123], v13 offset:18432
  ds_read_b64_tr_b16 v[124:125], v12 offset:18432
  ds_read_b64_tr_b16 v[126:127], v12 offset:19712
  ds_read_b64_tr_b16 v[128:129], v12 offset:18464
  ds_read_b64_tr_b16 v[130:131], v12 offset:19744
  ds_read_b64_tr_b16 v[132:133], v12 offset:18496
  ds_read_b64_tr_b16 v[134:135], v12 offset:19776
  ds_read_b64_tr_b16 v[136:137], v12 offset:18528
  ds_read_b64_tr_b16 v[138:139], v12 offset:19808
  ds_read_b64_tr_b16 v[140:141], v12 offset:18560
  ds_read_b64_tr_b16 v[142:143], v12 offset:19840
  s_mov_b32 s66, 296960
  s_add_u32 s64, s86, s66
  s_add_u32 m0, s70, 92160
  s_nop 0
  buffer_load_dwordx4 v241, s[40:43], s64 offen sc1 lds
  s_waitcnt lgkmcnt(11)
  v_mfma_f32_16x16x32_bf16 v[64:67], v[100:103], v[96:99], v[64:67]
  v_mfma_f32_16x16x32_bf16 v[68:71], v[104:107], v[96:99], v[68:71]
  s_cmp_lt_u32 s52, 2
  s_cbranch_scc0 L_g2d30
  s_mov_b32 s66, 296960
  s_add_u32 s64, s87, s66
  s_add_u32 s64, s64, 8192
  s_add_u32 m0, s70, 108544
  s_nop 0
  buffer_load_dwordx4 v241, s[40:43], s64 offen sc1 lds
L_g2d30:
  v_mfma_f32_16x16x32_bf16 v[72:75], v[108:111], v[96:99], v[72:75]
  v_mfma_f32_16x16x32_bf16 v[76:79], v[112:115], v[96:99], v[76:79]
  v_mfma_f32_16x16x32_bf16 v[80:83], v[116:119], v[96:99], v[80:83]
  s_mov_b32 s66, 296960
  s_add_u32 s64, s87, s66
  s_add_u32 m0, s70, 100352
  s_nop 0
  buffer_load_dwordx4 v241, s[40:43], s64 offen sc1 lds
  s_waitcnt vmcnt(8)
  s_waitcnt lgkmcnt(0)
  s_barrier
  ds_read_b128 v[96:99], v5 offset:0
  ds_read_b64_tr_b16 v[100:101], v4 offset:0
  ds_read_b64_tr_b16 v[102:103], v4 offset:1280
  ds_read_b64_tr_b16 v[104:105], v4 offset:32
  ds_read_b64_tr_b16 v[106:107], v4 offset:1312
  ds_read_b64_tr_b16 v[108:109], v4 offset:64
  ds_read_b64_tr_b16 v[110:111], v4 offset:1344
  ds_read_b64_tr_b16 v[112:113], v4 offset:96
  ds_read_b64_tr_b16 v[114:115], v4 offset:1376
  ds_read_b64_tr_b16 v[116:117], v4 offset:128
  ds_read_b64_tr_b16 v[118:119], v4 offset:1408
  s_mov_b32 s66, 307200
  s_add_u32 s64, s86, s66
  s_add_u32 m0, s70, 110592
  s_nop 0
  buffer_load_dwordx4 v241, s[40:43], s64 offen sc1 lds
  v_mfma_f32_16x16x32_bf16 v[64:67], v[124:127], v[120:123], v[64:67]
  v_mfma_f32_16x16x32_bf16 v[68:71], v[128:131], v[120:123], v[68:71]
  s_cmp_lt_u32 s52, 2
  s_cbranch_scc0 L_g2d31
  s_mov_b32 s66, 307200
  s_add_u32 s64, s87, s66
  s_add_u32 s64, s64, 8192
  s_add_u32 m0, s70, 126976
  s_nop 0
  buffer_load_dwordx4 v241, s[40:43], s64 offen sc1 lds
L_g2d31:
  v_mfma_f32_16x16x32_bf16 v[72:75], v[132:135], v[120:123], v[72:75]
  v_mfma_f32_16x16x32_bf16 v[76:79], v[136:139], v[120:123], v[76:79]
  v_mfma_f32_16x16x32_bf16 v[80:83], v[140:143], v[120:123], v[80:83]
  s_mov_b32 s66, 307200
  s_add_u32 s64, s87, s66
  s_add_u32 m0, s70, 118784
  s_nop 0
  buffer_load_dwordx4 v241, s[40:43], s64 offen sc1 lds
  ds_read_b128 v[120:123], v5 offset:18432
  ds_read_b64_tr_b16 v[124:125], v4 offset:18432
  ds_read_b64_tr_b16 v[126:127], v4 offset:19712
  ds_read_b64_tr_b16 v[128:129], v4 offset:18464
  ds_read_b64_tr_b16 v[130:131], v4 offset:19744
  ds_read_b64_tr_b16 v[132:133], v4 offset:18496
  ds_read_b64_tr_b16 v[134:135], v4 offset:19776
  ds_read_b64_tr_b16 v[136:137], v4 offset:18528
  ds_read_b64_tr_b16 v[138:139], v4 offset:19808
  ds_read_b64_tr_b16 v[140:141], v4 offset:18560
  ds_read_b64_tr_b16 v[142:143], v4 offset:19840
  s_mov_b32 s66, 317440
  s_add_u32 s64, s86, s66
  s_add_u32 m0, s70, 129024
  s_nop 0
  buffer_load_dwordx4 v241, s[40:43], s64 offen sc1 lds
  s_waitcnt lgkmcnt(11)
  v_mfma_f32_16x16x32_bf16 v[64:67], v[100:103], v[96:99], v[64:67]
  v_mfma_f32_16x16x32_bf16 v[68:71], v[104:107], v[96:99], v[68:71]
  s_cmp_lt_u32 s52, 2
  s_cbranch_scc0 L_g2d32
  s_mov_b32 s66, 317440
  s_add_u32 s64, s87, s66
  s_add_u32 s64, s64, 8192
  s_add_u32 m0, s70, 145408
  s_nop 0
  buffer_load_dwordx4 v241, s[40:43], s64 offen sc1 lds
L_g2d32:
  v_mfma_f32_16x16x32_bf16 v[72:75], v[108:111], v[96:99], v[72:75]
  v_mfma_f32_16x16x32_bf16 v[76:79], v[112:115], v[96:99], v[76:79]
  v_mfma_f32_16x16x32_bf16 v[80:83], v[116:119], v[96:99], v[80:83]
  s_mov_b32 s66, 317440
  s_add_u32 s64, s87, s66
  s_add_u32 m0, s70, 137216
  s_nop 0
  buffer_load_dwordx4 v241, s[40:43], s64 offen sc1 lds
  s_waitcnt vmcnt(8)
  s_waitcnt lgkmcnt(0)
  s_barrier
  ds_read_b128 v[96:99], v5 offset:36864
  ds_read_b64_tr_b16 v[100:101], v4 offset:36864
  ds_read_b64_tr_b16 v[102:103], v4 offset:38144
  ds_read_b64_tr_b16 v[104:105], v4 offset:36896
  ds_read_b64_tr_b16 v[106:107], v4 offset:38176
  ds_read_b64_tr_b16 v[108:109], v4 offset:36928
  ds_read_b64_tr_b16 v[110:111], v4 offset:38208
  ds_read_b64_tr_b16 v[112:113], v4 offset:36960
  ds_read_b64_tr_b16 v[114:115], v4 offset:38240
  ds_read_b64_tr_b16 v[116:117], v4 offset:36992
  ds_read_b64_tr_b16 v[118:119], v4 offset:38272
  s_mov_b32 s66, 327680
  s_add_u32 s64, s86, s66
  s_add_u32 m0, s70, 0
  s_nop 0
  buffer_load_dwordx4 v241, s[40:43], s64 offen sc1 lds
  v_mfma_f32_16x16x32_bf16 v[64:67], v[124:127], v[120:123], v[64:67]
  v_mfma_f32_16x16x32_bf16 v[68:71], v[128:131], v[120:123], v[68:71]
  s_cmp_lt_u32 s52, 2
  s_cbranch_scc0 L_g2d33
  s_mov_b32 s66, 327680
  s_add_u32 s64, s87, s66
  s_add_u32 s64, s64, 8192
  s_add_u32 m0, s70, 16384
  s_nop 0
  buffer_load_dwordx4 v241, s[40:43], s64 offen sc1 lds
L_g2d33:
  v_mfma_f32_16x16x32_bf16 v[72:75], v[132:135], v[120:123], v[72:75]
  v_mfma_f32_16x16x32_bf16 v[76:79], v[136:139], v[120:123], v[76:79]
  v_mfma_f32_16x16x32_bf16 v[80:83], v[140:143], v[120:123], v[80:83]
  s_mov_b32 s66, 327680
  s_add_u32 s64, s87, s66
  s_add_u32 m0, s70, 8192
  s_nop 0
  buffer_load_dwordx4 v241, s[40:43], s64 offen sc1 lds
  ds_read_b128 v[120:123], v11 offset:0
  ds_read_b64_tr_b16 v[124:125], v10 offset:0
  ds_read_b64_tr_b16 v[126:127], v10 offset:1280
  ds_read_b64_tr_b16 v[128:129], v10 offset:32
  ds_read_b64_tr_b16 v[130:131], v10 offset:1312
  ds_read_b64_tr_b16 v[132:133], v10 offset:64
  ds_read_b64_tr_b16 v[134:135], v10 offset:1344
  ds_read_b64_tr_b16 v[136:137], v10 offset:96
  ds_read_b64_tr_b16 v[138:139], v10 offset:1376
  ds_read_b64_tr_b16 v[140:141], v10 offset:128
  ds_read_b64_tr_b16 v[142:143], v10 offset:1408
  s_mov_b32 s66, 337920
  s_add_u32 s64, s86, s66
  s_add_u32 m0, s70, 18432
  s_nop 0
  buffer_load_dwordx4 v241, s[40:43], s64 offen sc1 lds
  s_waitcnt lgkmcnt(11)
  v_mfma_f32_16x16x32_bf16 v[64:67], v[100:103], v[96:99], v[64:67]
  v_mfma_f32_16x16x32_bf16 v[68:71], v[104:107], v[96:99], v[68:71]
  s_cmp_lt_u32 s52, 2
  s_cbranch_scc0 L_g2d34
  s_mov_b32 s66, 337920
  s_add_u32 s64, s87, s66
  s_add_u32 s64, s64, 8192
  s_add_u32 m0, s70, 34816
  s_nop 0
  buffer_load_dwordx4 v241, s[40:43], s64 offen sc1 lds
L_g2d34:
  v_mfma_f32_16x16x32_bf16 v[72:75], v[108:111], v[96:99], v[72:75]
  v_mfma_f32_16x16x32_bf16 v[76:79], v[112:115], v[96:99], v[76:79]
  v_mfma_f32_16x16x32_bf16 v[80:83], v[116:119], v[96:99], v[80:83]
  s_mov_b32 s66, 337920
  s_add_u32 s64, s87, s66
  s_add_u32 m0, s70, 26624
  s_nop 0
  buffer_load_dwordx4 v241, s[40:43], s64 offen sc1 lds
  s_waitcnt vmcnt(8)
  s_waitcnt lgkmcnt(0)
  s_barrier
  ds_read_b128 v[96:99], v11 offset:18432
  ds_read_b64_tr_b16 v[100:101], v10 offset:18432
  ds_read_b64_tr_b16 v[102:103], v10 offset:19712
  ds_read_b64_tr_b16 v[104:105], v10 offset:18464
  ds_read_b64_tr_b16 v[106:107], v10 offset:19744
  ds_read_b64_tr_b16 v[108:109], v10 offset:18496
  ds_read_b64_tr_b16 v[110:111], v10 offset:19776
  ds_read_b64_tr_b16 v[112:113], v10 offset:18528
  ds_read_b64_tr_b16 v[114:115], v10 offset:19808
  ds_read_b64_tr_b16 v[116:117], v10 offset:18560
  ds_read_b64_tr_b16 v[118:119], v10 offset:19840
  s_mov_b32 s66, 348160
  s_add_u32 s64, s86, s66
  s_add_u32 m0, s70, 36864
  s_nop 0
  buffer_load_dwordx4 v241, s[40:43], s64 offen sc1 lds
  v_mfma_f32_16x16x32_bf16 v[64:67], v[124:127], v[120:123], v[64:67]
  v_mfma_f32_16x16x32_bf16 v[68:71], v[128:131], v[120:123], v[68:71]
  s_cmp_lt_u32 s52, 2
  s_cbranch_scc0 L_g2d35
  s_mov_b32 s66, 348160
  s_add_u32 s64, s87, s66
  s_add_u32 s64, s64, 8192
  s_add_u32 m0, s70, 53248
  s_nop 0
  buffer_load_dwordx4 v241, s[40:43], s64 offen sc1 lds
L_g2d35:
  v_mfma_f32_16x16x32_bf16 v[72:75], v[132:135], v[120:123], v[72:75]
  v_mfma_f32_16x16x32_bf16 v[76:79], v[136:139], v[120:123], v[76:79]
  v_mfma_f32_16x16x32_bf16 v[80:83], v[140:143], v[120:123], v[80:83]
  s_mov_b32 s66, 348160
  s_add_u32 s64, s87, s66
  s_add_u32 m0, s70, 45056
  s_nop 0
  buffer_load_dwordx4 v241, s[40:43], s64 offen sc1 lds
  ds_read_b128 v[120:123], v11 offset:36864
  ds_read_b64_tr_b16 v[124:125], v10 offset:36864
  ds_read_b64_tr_b16 v[126:127], v10 offset:38144
  ds_read_b64_tr_b16 v[128:129], v10 offset:36896
  ds_read_b64_tr_b16 v[130:131], v10 offset:38176
  ds_read_b64_tr_b16 v[132:133], v10 offset:36928
  ds_read_b64_tr_b16 v[134:135], v10 offset:38208
  ds_read_b64_tr_b16 v[136:137], v10 offset:36960
  ds_read_b64_tr_b16 v[138:139], v10 offset:38240
  ds_read_b64_tr_b16 v[140:141], v10 offset:36992
  ds_read_b64_tr_b16 v[142:143], v10 offset:38272
  s_mov_b32 s66, 358400
  s_add_u32 s64, s86, s66
  s_add_u32 m0, s70, 55296
  s_nop 0
  buffer_load_dwordx4 v241, s[40:43], s64 offen sc1 lds
  s_waitcnt lgkmcnt(11)
  v_mfma_f32_16x16x32_bf16 v[64:67], v[100:103], v[96:99], v[64:67]
  v_mfma_f32_16x16x32_bf16 v[68:71], v[104:107], v[96:99], v[68:71]
  s_cmp_lt_u32 s52, 2
  s_cbranch_scc0 L_g2d36
  s_mov_b32 s66, 358400
  s_add_u32 s64, s87, s66
  s_add_u32 s64, s64, 8192
  s_add_u32 m0, s70, 71680
  s_nop 0
  buffer_load_dwordx4 v241, s[40:43], s64 offen sc1 lds
L_g2d36:
  v_mfma_f32_16x16x32_bf16 v[72:75], v[108:111], v[96:99], v[72:75]
  v_mfma_f32_16x16x32_bf16 v[76:79], v[112:115], v[96:99], v[76:79]
  v_mfma_f32_16x16x32_bf16 v[80:83], v[116:119], v[96:99], v[80:83]
  s_mov_b32 s66, 358400
  s_add_u32 s64, s87, s66
  s_add_u32 m0, s70, 63488
  s_nop 0
  buffer_load_dwordx4 v241, s[40:43], s64 offen sc1 lds
  s_waitcnt vmcnt(8)
  s_waitcnt lgkmcnt(0)
  s_barrier
  ds_read_b128 v[96:99], v13 offset:0
  ds_read_b64_tr_b16 v[100:101], v12 offset:0
  ds_read_b64_tr_b16 v[102:103], v12 offset:1280
  ds_read_b64_tr_b16 v[104:105], v12 offset:32
  ds_read_b64_tr_b16 v[106:107], v12 offset:1312
  ds_read_b64_tr_b16 v[108:109], v12 offset:64
  ds_read_b64_tr_b16 v[110:111], v12 offset:1344
  ds_read_b64_tr_b16 v[112:113], v12 offset:96
  ds_read_b64_tr_b16 v[114:115], v12 offset:1376
  ds_read_b64_tr_b16 v[116:117], v12 offset:128
  ds_read_b64_tr_b16 v[118:119], v12 offset:1408
  s_mov_b32 s66, 368640
  s_add_u32 s64, s86, s66
  s_add_u32 m0, s70, 73728
  s_nop 0
  buffer_load_dwordx4 v241, s[40:43], s64 offen sc1 lds
  v_mfma_f32_16x16x32_bf16 v[64:67], v[124:127], v[120:123], v[64:67]
  v_mfma_f32_16x16x32_bf16 v[68:71], v[128:131], v[120:123], v[68:71]
  s_cmp_lt_u32 s52, 2
  s_cbranch_scc0 L_g2d37
  s_mov_b32 s66, 368640
  s_add_u32 s64, s87, s66
  s_add_u32 s64, s64, 8192
  s_add_u32 m0, s70, 90112
  s_nop 0
  buffer_load_dwordx4 v241, s[40:43], s64 offen sc1 lds
L_g2d37:
  v_mfma_f32_16x16x32_bf16 v[72:75], v[132:135], v[120:123], v[72:75]
  v_mfma_f32_16x16x32_bf16 v[76:79], v[136:139], v[120:123], v[76:79]
  v_mfma_f32_16x16x32_bf16 v[80:83], v[140:143], v[120:123], v[80:83]
  s_mov_b32 s66, 368640
  s_add_u32 s64, s87, s66
  s_add_u32 m0, s70, 81920
  s_nop 0
  buffer_load_dwordx4 v241, s[40:43], s64 offen sc1 lds
  ds_read_b128 v[120:123], v13 offset:18432
  ds_read_b64_tr_b16 v[124:125], v12 offset:18432
  ds_read_b64_tr_b16 v[126:127], v12 offset:19712
  ds_read_b64_tr_b16 v[128:129], v12 offset:18464
  ds_read_b64_tr_b16 v[130:131], v12 offset:19744
  ds_read_b64_tr_b16 v[132:133], v12 offset:18496
  ds_read_b64_tr_b16 v[134:135], v12 offset:19776
  ds_read_b64_tr_b16 v[136:137], v12 offset:18528
  ds_read_b64_tr_b16 v[138:139], v12 offset:19808
  ds_read_b64_tr_b16 v[140:141], v12 offset:18560
  ds_read_b64_tr_b16 v[142:143], v12 offset:19840
  s_mov_b32 s66, 378880
  s_add_u32 s64, s86, s66
  s_add_u32 m0, s70, 92160
  s_nop 0
  buffer_load_dwordx4 v241, s[40:43], s64 offen sc1 lds
  s_waitcnt lgkmcnt(11)
  v_mfma_f32_16x16x32_bf16 v[64:67], v[100:103], v[96:99], v[64:67]
  v_mfma_f32_16x16x32_bf16 v[68:71], v[104:107], v[96:99], v[68:71]
  s_cmp_lt_u32 s52, 2
  s_cbranch_scc0 L_g2d38
  s_mov_b32 s66, 378880
  s_add_u32 s64, s87, s66
  s_add_u32 s64, s64, 8192
  s_add_u32 m0, s70, 108544
  s_nop 0
  buffer_load_dwordx4 v241, s[40:43], s64 offen sc1 lds
L_g2d38:
  v_mfma_f32_16x16x32_bf16 v[72:75], v[108:111], v[96:99], v[72:75]
  v_mfma_f32_16x16x32_bf16 v[76:79], v[112:115], v[96:99], v[76:79]
  v_mfma_f32_16x16x32_bf16 v[80:83], v[116:119], v[96:99], v[80:83]
  s_mov_b32 s66, 378880
  s_add_u32 s64, s87, s66
  s_add_u32 m0, s70, 100352
  s_nop 0
  buffer_load_dwordx4 v241, s[40:43], s64 offen sc1 lds
  s_waitcnt vmcnt(8)
  s_waitcnt lgkmcnt(0)
  s_barrier
  ds_read_b128 v[96:99], v5 offset:0
  ds_read_b64_tr_b16 v[100:101], v4 offset:0
  ds_read_b64_tr_b16 v[102:103], v4 offset:1280
  ds_read_b64_tr_b16 v[104:105], v4 offset:32
  ds_read_b64_tr_b16 v[106:107], v4 offset:1312
  ds_read_b64_tr_b16 v[108:109], v4 offset:64
  ds_read_b64_tr_b16 v[110:111], v4 offset:1344
  ds_read_b64_tr_b16 v[112:113], v4 offset:96
  ds_read_b64_tr_b16 v[114:115], v4 offset:1376
  ds_read_b64_tr_b16 v[116:117], v4 offset:128
  ds_read_b64_tr_b16 v[118:119], v4 offset:1408
  s_mov_b32 s66, 389120
  s_add_u32 s64, s86, s66
  s_add_u32 m0, s70, 110592
  s_nop 0
  buffer_load_dwordx4 v241, s[40:43], s64 offen sc1 lds
  v_mfma_f32_16x16x32_bf16 v[64:67], v[124:127], v[120:123], v[64:67]
  v_mfma_f32_16x16x32_bf16 v[68:71], v[128:131], v[120:123], v[68:71]
  s_cmp_lt_u32 s52, 2
  s_cbranch_scc0 L_g2d39
  s_mov_b32 s66, 389120
  s_add_u32 s64, s87, s66
  s_add_u32 s64, s64, 8192
  s_add_u32 m0, s70, 126976
  s_nop 0
  buffer_load_dwordx4 v241, s[40:43], s64 offen sc1 lds
L_g2d39:
  v_mfma_f32_16x16x32_bf16 v[72:75], v[132:135], v[120:123], v[72:75]
  v_mfma_f32_16x16x32_bf16 v[76:79], v[136:139], v[120:123], v[76:79]
  v_mfma_f32_16x16x32_bf16 v[80:83], v[140:143], v[120:123], v[80:83]
  s_mov_b32 s66, 389120
  s_add_u32 s64, s87, s66
  s_add_u32 m0, s70, 118784
  s_nop 0
  buffer_load_dwordx4 v241, s[40:43], s64 offen sc1 lds
  ds_read_b128 v[120:123], v5 offset:18432
  ds_read_b64_tr_b16 v[124:125], v4 offset:18432
  ds_read_b64_tr_b16 v[126:127], v4 offset:19712
  ds_read_b64_tr_b16 v[128:129], v4 offset:18464
  ds_read_b64_tr_b16 v[130:131], v4 offset:19744
  ds_read_b64_tr_b16 v[132:133], v4 offset:18496
  ds_read_b64_tr_b16 v[134:135], v4 offset:19776
  ds_read_b64_tr_b16 v[136:137], v4 offset:18528
  ds_read_b64_tr_b16 v[138:139], v4 offset:19808
  ds_read_b64_tr_b16 v[140:141], v4 offset:18560
  ds_read_b64_tr_b16 v[142:143], v4 offset:19840
  s_waitcnt lgkmcnt(11)
  v_mfma_f32_16x16x32_bf16 v[64:67], v[100:103], v[96:99], v[64:67]
  v_mfma_f32_16x16x32_bf16 v[68:71], v[104:107], v[96:99], v[68:71]
  v_mfma_f32_16x16x32_bf16 v[72:75], v[108:111], v[96:99], v[72:75]
  v_mfma_f32_16x16x32_bf16 v[76:79], v[112:115], v[96:99], v[76:79]
  v_mfma_f32_16x16x32_bf16 v[80:83], v[116:119], v[96:99], v[80:83]
  s_waitcnt vmcnt(6)
  s_waitcnt lgkmcnt(0)
  s_barrier
  ds_read_b128 v[96:99], v5 offset:36864
  ds_read_b64_tr_b16 v[100:101], v4 offset:36864
  ds_read_b64_tr_b16 v[102:103], v4 offset:38144
  ds_read_b64_tr_b16 v[104:105], v4 offset:36896
  ds_read_b64_tr_b16 v[106:107], v4 offset:38176
  ds_read_b64_tr_b16 v[108:109], v4 offset:36928
  ds_read_b64_tr_b16 v[110:111], v4 offset:38208
  ds_read_b64_tr_b16 v[112:113], v4 offset:36960
  ds_read_b64_tr_b16 v[114:115], v4 offset:38240
  ds_read_b64_tr_b16 v[116:117], v4 offset:36992
  ds_read_b64_tr_b16 v[118:119], v4 offset:38272
  v_mfma_f32_16x16x32_bf16 v[64:67], v[124:127], v[120:123], v[64:67]
  v_mfma_f32_16x16x32_bf16 v[68:71], v[128:131], v[120:123], v[68:71]
  v_mfma_f32_16x16x32_bf16 v[72:75], v[132:135], v[120:123], v[72:75]
  v_mfma_f32_16x16x32_bf16 v[76:79], v[136:139], v[120:123], v[76:79]
  v_mfma_f32_16x16x32_bf16 v[80:83], v[140:143], v[120:123], v[80:83]
  ds_read_b128 v[120:123], v11 offset:0
  ds_read_b64_tr_b16 v[124:125], v10 offset:0
  ds_read_b64_tr_b16 v[126:127], v10 offset:1280
  ds_read_b64_tr_b16 v[128:129], v10 offset:32
  ds_read_b64_tr_b16 v[130:131], v10 offset:1312
  ds_read_b64_tr_b16 v[132:133], v10 offset:64
  ds_read_b64_tr_b16 v[134:135], v10 offset:1344
  ds_read_b64_tr_b16 v[136:137], v10 offset:96
  ds_read_b64_tr_b16 v[138:139], v10 offset:1376
  ds_read_b64_tr_b16 v[140:141], v10 offset:128
  ds_read_b64_tr_b16 v[142:143], v10 offset:1408
  s_waitcnt lgkmcnt(11)
  v_mfma_f32_16x16x32_bf16 v[64:67], v[100:103], v[96:99], v[64:67]
  v_mfma_f32_16x16x32_bf16 v[68:71], v[104:107], v[96:99], v[68:71]
  v_mfma_f32_16x16x32_bf16 v[72:75], v[108:111], v[96:99], v[72:75]
  v_mfma_f32_16x16x32_bf16 v[76:79], v[112:115], v[96:99], v[76:79]
  v_mfma_f32_16x16x32_bf16 v[80:83], v[116:119], v[96:99], v[80:83]
  s_waitcnt vmcnt(2)
  s_waitcnt lgkmcnt(0)
  s_barrier
  ds_read_b128 v[96:99], v11 offset:18432
  ds_read_b64_tr_b16 v[100:101], v10 offset:18432
  ds_read_b64_tr_b16 v[102:103], v10 offset:19712
  ds_read_b64_tr_b16 v[104:105], v10 offset:18464
  ds_read_b64_tr_b16 v[106:107], v10 offset:19744
  ds_read_b64_tr_b16 v[108:109], v10 offset:18496
  ds_read_b64_tr_b16 v[110:111], v10 offset:19776
  ds_read_b64_tr_b16 v[112:113], v10 offset:18528
  ds_read_b64_tr_b16 v[114:115], v10 offset:19808
  ds_read_b64_tr_b16 v[116:117], v10 offset:18560
  ds_read_b64_tr_b16 v[118:119], v10 offset:19840
  v_mfma_f32_16x16x32_bf16 v[64:67], v[124:127], v[120:123], v[64:67]
  v_mfma_f32_16x16x32_bf16 v[68:71], v[128:131], v[120:123], v[68:71]
  v_mfma_f32_16x16x32_bf16 v[72:75], v[132:135], v[120:123], v[72:75]
  v_mfma_f32_16x16x32_bf16 v[76:79], v[136:139], v[120:123], v[76:79]
  v_mfma_f32_16x16x32_bf16 v[80:83], v[140:143], v[120:123], v[80:83]
  ds_read_b128 v[120:123], v11 offset:36864
  ds_read_b64_tr_b16 v[124:125], v10 offset:36864
  ds_read_b64_tr_b16 v[126:127], v10 offset:38144
  ds_read_b64_tr_b16 v[128:129], v10 offset:36896
  ds_read_b64_tr_b16 v[130:131], v10 offset:38176
  ds_read_b64_tr_b16 v[132:133], v10 offset:36928
  ds_read_b64_tr_b16 v[134:135], v10 offset:38208
  ds_read_b64_tr_b16 v[136:137], v10 offset:36960
  ds_read_b64_tr_b16 v[138:139], v10 offset:38240
  ds_read_b64_tr_b16 v[140:141], v10 offset:36992
  ds_read_b64_tr_b16 v[142:143], v10 offset:38272
  s_waitcnt lgkmcnt(11)
  v_mfma_f32_16x16x32_bf16 v[64:67], v[100:103], v[96:99], v[64:67]
  v_mfma_f32_16x16x32_bf16 v[68:71], v[104:107], v[96:99], v[68:71]
  v_mfma_f32_16x16x32_bf16 v[72:75], v[108:111], v[96:99], v[72:75]
  v_mfma_f32_16x16x32_bf16 v[76:79], v[112:115], v[96:99], v[76:79]
  v_mfma_f32_16x16x32_bf16 v[80:83], v[116:119], v[96:99], v[80:83]
  s_waitcnt vmcnt(0)
  s_waitcnt lgkmcnt(0)
  s_barrier
  ds_read_b128 v[96:99], v13 offset:0
  ds_read_b64_tr_b16 v[100:101], v12 offset:0
  ds_read_b64_tr_b16 v[102:103], v12 offset:1280
  ds_read_b64_tr_b16 v[104:105], v12 offset:32
  ds_read_b64_tr_b16 v[106:107], v12 offset:1312
  ds_read_b64_tr_b16 v[108:109], v12 offset:64
  ds_read_b64_tr_b16 v[110:111], v12 offset:1344
  ds_read_b64_tr_b16 v[112:113], v12 offset:96
  ds_read_b64_tr_b16 v[114:115], v12 offset:1376
  ds_read_b64_tr_b16 v[116:117], v12 offset:128
  ds_read_b64_tr_b16 v[118:119], v12 offset:1408
  v_mfma_f32_16x16x32_bf16 v[64:67], v[124:127], v[120:123], v[64:67]
  v_mfma_f32_16x16x32_bf16 v[68:71], v[128:131], v[120:123], v[68:71]
  v_mfma_f32_16x16x32_bf16 v[72:75], v[132:135], v[120:123], v[72:75]
  v_mfma_f32_16x16x32_bf16 v[76:79], v[136:139], v[120:123], v[76:79]
  v_mfma_f32_16x16x32_bf16 v[80:83], v[140:143], v[120:123], v[80:83]
  s_waitcnt lgkmcnt(0)
  v_mfma_f32_16x16x32_bf16 v[64:67], v[100:103], v[96:99], v[64:67]
  v_mfma_f32_16x16x32_bf16 v[68:71], v[104:107], v[96:99], v[68:71]
  v_mfma_f32_16x16x32_bf16 v[72:75], v[108:111], v[96:99], v[72:75]
  v_mfma_f32_16x16x32_bf16 v[76:79], v[112:115], v[96:99], v[76:79]
  v_mfma_f32_16x16x32_bf16 v[80:83], v[116:119], v[96:99], v[80:83]
  v_lshlrev_b32 v4, 4, v0
  s_mul_i32 s64, s53, 5120
  v_add_u32 v4, s64, v4
  v_and_b32 v6, 15, v0
  v_lshrrev_b32 v7, 4, v0
  v_mul_u32_u24 v8, 1280, v6
  v_lshl_add_u32 v8, v7, 3, v8
  s_mov_b32 s80, s18
  s_and_b32 s81, s19, 0xffff
  s_mov_b32 s82, 2621440
  s_mov_b32 s83, 0x20000
  s_lshl_b32 s67, s61, 6
  s_lshl_b32 s65, s53, 4
  s_add_u32 s67, s67, s65
  s_mul_i32 s67, s67, 1280
  s_mul_i32 s68, s62, 160
  s_add_u32 s67, s67, s68
  s_barrier
  s_cmp_eq_u32 s54, 0
  s_cbranch_scc1 L_g2_lo
  ds_write_b128 v4, v[64:67] offset:0
  ds_write_b128 v4, v[68:71] offset:1024
  ds_write_b128 v4, v[72:75] offset:2048
  ds_write_b128 v4, v[76:79] offset:3072
  ds_write_b128 v4, v[80:83] offset:4096
  s_waitcnt lgkmcnt(0)
  s_barrier
  s_branch L_g2_done
L_g2_lo:
  buffer_load_dwordx2 v[24:25], v8, s[24:27], s67 offen offset:0
  buffer_load_dwordx2 v[26:27], v8, s[24:27], s67 offen offset:32
  buffer_load_dwordx2 v[28:29], v8, s[24:27], s67 offen offset:64
  buffer_load_dwordx2 v[30:31], v8, s[24:27], s67 offen offset:96
  buffer_load_dwordx2 v[32:33], v8, s[24:27], s67 offen offset:128
  s_barrier
  ds_read_b128 v[96:99], v4 offset:0
  ds_read_b128 v[100:103], v4 offset:1024
  ds_read_b128 v[104:107], v4 offset:2048
  ds_read_b128 v[108:111], v4 offset:3072
  ds_read_b128 v[112:115], v4 offset:4096
  s_waitcnt vmcnt(0) lgkmcnt(0)
  v_lshlrev_b32 v20, 16, v24
  v_and_b32 v21, 0xffff0000, v24
  v_lshlrev_b32 v22, 16, v25
  v_and_b32 v23, 0xffff0000, v25
  v_add_f32 v64, v64, v96
  v_add_f32 v65, v65, v97
  v_add_f32 v66, v66, v98
  v_add_f32 v67, v67, v99
  v_add_f32 v64, v64, v20
  v_add_f32 v65, v65, v21
  v_add_f32 v66, v66, v22
  v_add_f32 v67, v67, v23
  v_cvt_pk_bf16_f32 v64, v64, v65
  v_cvt_pk_bf16_f32 v65, v66, v67
  buffer_store_dwordx2 v[64:65], v8, s[80:83], s67 offen offset:0
  v_lshlrev_b32 v20, 16, v26
  v_and_b32 v21, 0xffff0000, v26
  v_lshlrev_b32 v22, 16, v27
  v_and_b32 v23, 0xffff0000, v27
  v_add_f32 v68, v68, v100
  v_add_f32 v69, v69, v101
  v_add_f32 v70, v70, v102
  v_add_f32 v71, v71, v103
  v_add_f32 v68, v68, v20
  v_add_f32 v69, v69, v21
  v_add_f32 v70, v70, v22
  v_add_f32 v71, v71, v23
  v_cvt_pk_bf16_f32 v68, v68, v69
  v_cvt_pk_bf16_f32 v69, v70, v71
  buffer_store_dwordx2 v[68:69], v8, s[80:83], s67 offen offset:32
  v_lshlrev_b32 v20, 16, v28
  v_and_b32 v21, 0xffff0000, v28
  v_lshlrev_b32 v22, 16, v29
  v_and_b32 v23, 0xffff0000, v29
  v_add_f32 v72, v72, v104
  v_add_f32 v73, v73, v105
  v_add_f32 v74, v74, v106
  v_add_f32 v75, v75, v107
  v_add_f32 v72, v72, v20
  v_add_f32 v73, v73, v21
  v_add_f32 v74, v74, v22
  v_add_f32 v75, v75, v23
  v_cvt_pk_bf16_f32 v72, v72, v73
  v_cvt_pk_bf16_f32 v73, v74, v75
  buffer_store_dwordx2 v[72:73], v8, s[80:83], s67 offen offset:64
  v_lshlrev_b32 v20, 16, v30
  v_and_b32 v21, 0xffff0000, v30
  v_lshlrev_b32 v22, 16, v31
  v_and_b32 v23, 0xffff0000, v31
  v_add_f32 v76, v76, v108
  v_add_f32 v77, v77, v109
  v_add_f32 v78, v78, v110
  v_add_f32 v79, v79, v111
  v_add_f32 v76, v76, v20
  v_add_f32 v77, v77, v21
  v_add_f32 v78, v78, v22
  v_add_f32 v79, v79, v23
  v_cvt_pk_bf16_f32 v76, v76, v77
  v_cvt_pk_bf16_f32 v77, v78, v79
  buffer_store_dwordx2 v[76:77], v8, s[80:83], s67 offen offset:96
  v_lshlrev_b32 v20, 16, v32
  v_and_b32 v21, 0xffff0000, v32
  v_lshlrev_b32 v22, 16, v33
  v_and_b32 v23, 0xffff0000, v33
  v_add_f32 v80, v80, v112
  v_add_f32 v81, v81, v113
  v_add_f32 v82, v82, v114
  v_add_f32 v83, v83, v115
  v_add_f32 v80, v80, v20
  v_add_f32 v81, v81, v21
  v_add_f32 v82, v82, v22
  v_add_f32 v83, v83, v23
  v_cvt_pk_bf16_f32 v80, v80, v81
  v_cvt_pk_bf16_f32 v81, v82, v83
  buffer_store_dwordx2 v[80:81], v8, s[80:83], s67 offen offset:128
L_g2_done:
L_end:
  s_endpgm
.section .rodata,"a"
.p2align 6
.amdhsa_kernel parallel_sum__sliding_block__glu_gated_bilinear__prompt_kernel
  .amdhsa_next_free_vgpr 256
  .amdhsa_next_free_sgpr 102
  .amdhsa_accum_offset 256
  .amdhsa_group_segment_fixed_size 0
  .amdhsa_kernarg_size 80
  .amdhsa_user_sgpr_count 2
  .amdhsa_user_sgpr_kernarg_segment_ptr 1
  .amdhsa_system_sgpr_workgroup_id_x 1
.end_amdhsa_kernel
```
